```python
import torch

def _softmax(x, axis=-1):
    return torch.softmax(x, dim=axis)
def _gelu(x):
    return torch.nn.functional.gelu(x, approximate="tanh")
def _silu(x):
    return torch.nn.functional.silu(x)
def _sigmoid(x):
    return torch.sigmoid(x)
def _layernorm(x, axis=-1, eps=1e-5):
    m = x.mean(dim=axis, keepdim=True)
    v = x.var(dim=axis, keepdim=True, unbiased=False)
    return (x - m) / torch.sqrt(v + eps)
def _scatter_add(tgt, idx, src, axis=0):
    return tgt.clone().index_add_(axis, idx, src)
def _segment_sum(src, seg, n):
    out = torch.zeros((n,) + src.shape[1:], dtype=src.dtype)
    return out.index_add_(0, seg, src)
def _pad(x, pw):
    flat = tuple(v for pair in reversed(pw) for v in pair)
    return torch.nn.functional.pad(x, flat)

kernel_name = 'recurrent_scan__sliding_block_cached__swiglu_ffn__decode'

def setup_inputs():

    _w = (lambda a: (lambda t: t.to(torch.bfloat16) if t.is_floating_point() else t)(torch.as_tensor(a)))
    def _A_setup():
        B, Sq, D = 4, 1, 512
        Hq, Hkv, Sk, Dh = 32, 8, 8192, 128
        assert Hq % Hkv == 0, (Hq, Hkv)
        return {
            "x": _w((lambda *s: torch.randn(*s, dtype=torch.bfloat16) * 0.05)(B, Sq, D)),
            "k_cache": _w((lambda *s: torch.randn(*s, dtype=torch.bfloat16) * 1.6)(B, Hkv, Sk, Dh)),
            "v_cache": _w((lambda *s: torch.randn(*s, dtype=torch.bfloat16) * 0.2)(B, Hkv, Sk, Dh)),
            "wq": _w((lambda *s: torch.randn(*s, dtype=torch.bfloat16) * 1.6)(D, Hq * Dh) * (D ** -0.5)),
            "wo": _w((lambda *s: torch.randn(*s, dtype=torch.bfloat16) * 0.2)(Hq * Dh, D) * ((Hq * Dh) ** -0.5)),
        }
    _A_in = _A_setup()

    def _B_setup():
        B, S, D, F = 4, 1, 512, 1792
        return {
            "x": _w((lambda *s: torch.randn(*s, dtype=torch.bfloat16) * 0.05)(B, S, D)),
            "w_gate": _w((lambda *s: torch.randn(*s, dtype=torch.bfloat16) * 0.1)(D, F)),
            "w_up": _w((lambda *s: torch.randn(*s, dtype=torch.bfloat16) * 0.1)(D, F)),
            "w_down": _w((lambda *s: torch.randn(*s, dtype=torch.bfloat16) * 0.1)(F, D)),
        }
    _B_in = _B_setup()

    return {
        "A_x": _A_in["x"],
        "A_k_cache": _A_in["k_cache"],
        "A_v_cache": _A_in["v_cache"],
        "A_wq": _A_in["wq"],
        "A_wo": _A_in["wo"],
        "B_x": _B_in["x"],
        "B_w_gate": _B_in["w_gate"],
        "B_w_up": _B_in["w_up"],
        "B_w_down": _B_in["w_down"],
    }

def reference(A_x, A_k_cache, A_v_cache, A_wq, A_wo, B_x, B_w_gate, B_w_up, B_w_down):
    def _A_ref(x, k_cache, v_cache, wq, wo):
        B, Sq, D = x.shape
        Hq, Dh = 32, 128
        Hkv, Sk = k_cache.shape[1], k_cache.shape[2]
        W = min(4096, max(256, Sk // 4))
        rep = Hq // Hkv
        q = (lambda x, *d: x.permute(*d))((x @ wq).reshape(B, Sq, Hq, Dh), 0, 2, 1, 3)
        k = (lambda x, n, axis: torch.repeat_interleave(x, n, dim=axis))(k_cache[:, :, Sk - W:, :], rep, axis=1)
        v = (lambda x, n, axis: torch.repeat_interleave(x, n, dim=axis))(v_cache[:, :, Sk - W:, :], rep, axis=1)
        scores = torch.einsum("bhqd,bhkd->bhqk", q, k) * (Dh ** -0.5)
        p = _softmax(scores, axis=-1)
        o = torch.einsum("bhqk,bhkd->bhqd", p, v)
        return (lambda x, *d: x.permute(*d))(o, 0, 2, 1, 3).reshape(B, Sq, Hq * Dh) @ wo

    def _B_ref(x, w_gate, w_up, w_down):
        g = _silu(x @ w_gate)
        u = x @ w_up
        return (g * u) @ w_down

    x = A_x
    xn = _layernorm(x, axis=-1)
    s = _A_ref(xn, A_k_cache, A_v_cache, A_wq, A_wo)
    g = _silu(_B_ref(xn, B_w_gate, B_w_up, B_w_down))
    return x + s * g
```

```asm
; @launch grid=(256,1,1) block=(768,1,1) lds=25856
.amdgcn_target "amdgcn-amd-amdhsa--gfx950"
.text
.globl recurrent_scan__sliding_block_cached__swiglu_ffn__decode_kernel
.p2align 8
.type recurrent_scan__sliding_block_cached__swiglu_ffn__decode_kernel,@function
recurrent_scan__sliding_block_cached__swiglu_ffn__decode_kernel:
    s_cmp_ge_u32 s2, 256
    s_cbranch_scc1 L_end
    s_load_dwordx16 s[4:19], s[0:1], 0
    s_load_dwordx8 s[20:27], s[0:1], 64
    v_lshrrev_b32 v2, 6, v0
    v_and_b32 v1, 63, v0
    v_readfirstlane_b32 s3, v2
    v_mov_b32 v14, 0
    v_mov_b32 v15, 0
    v_lshlrev_b32 v6, 3, v1
    s_and_b32 s28, s2, 7
    s_lshr_b32 s29, s2, 3
    s_cmp_lg_u32 s3, 0
    s_cbranch_scc1 L_noinit
    ds_write_b64 v6, v[14:15]
L_noinit:
    s_cmp_lg_u32 s3, 11
    s_cbranch_scc1 L_nopf
    s_getpc_b64 s[60:61]
    v_lshlrev_b32 v7, 7, v1
    global_load_dword v13, v7, s[60:61]
    v_add_u32 v7, 0x2000, v7
    global_load_dword v12, v7, s[60:61]
L_nopf:
    v_and_b32 v2, 15, v1
    v_lshrrev_b32 v3, 4, v1
    v_mov_b32 v15, 1
    s_mov_b32 s50, 0x05040100
    s_mov_b32 s51, 0x07060302
    s_mov_b32 s52, 0x3fb8aa3b
    s_cmp_ge_u32 s3, 4
    s_cbranch_scc1 L_kv
    s_setprio 3
    v_lshlrev_b32 v4, 4, v1
    v_and_b32 v5, 7, v2
    v_lshrrev_b32 v6, 3, v2
    s_cmp_ge_u32 s29, 30
    s_cbranch_scc1 L_sp
    s_lshl_b32 s34, s3, 10
    s_cmp_ge_u32 s29, 16
    s_cbranch_scc1 L_a1
    s_cmp_eq_u32 s29, 7
    s_cselect_b32 s41, 11, s29
    s_cmp_eq_u32 s29, 11
    s_cselect_b32 s41, 7, s41
    s_and_b32 s40, s28, 3
    s_lshl_b32 s40, s40, 4
    s_add_u32 s40, s40, s41
    s_and_b32 s43, s28, 4
    s_add_u32 s43, s43, s3
    s_lshl_b32 s41, s43, 19
    s_lshl_b32 s42, s40, 7
    s_add_u32 s41, s41, s42
    s_movk_i32 s56, 8192
    s_movk_i32 s42, 32
    s_lshl_b32 s43, s43, 7
    s_waitcnt lgkmcnt(0)
    s_add_u32 s38, s4, s34
    s_addc_u32 s39, s5, 0
    global_load_dwordx4 v[152:155], v4, s[38:39]
    v_mul_u32_u24 v10, s42, v6
    v_lshl_add_u32 v10, v3, 3, v10
    v_mul_u32_u24 v10, s56, v10
    v_lshl_add_u32 v10, v5, 4, v10
    v_add_u32 v10, s41, v10
    v_mov_b32 v8, s10
    v_mov_b32 v9, s11
    s_mul_i32 s36, s56, 25
    s_mov_b32 s57, 0
    s_mov_b32 s37, 0
    v_add_co_u32 v8, vcc, v8, v10
    s_nop 1
    v_addc_co_u32 v9, vcc, 0, v9, vcc
    s_load_dword s54, s[26:27], 0
    global_load_dwordx4 v[16:19], v[8:9], off nt
    v_lshl_add_u64 v[8:9], v[8:9], 0, s[56:57]
    global_load_dwordx4 v[20:23], v[8:9], off nt
    v_lshl_add_u64 v[8:9], v[8:9], 0, s[56:57]
    global_load_dwordx4 v[24:27], v[8:9], off nt
    v_lshl_add_u64 v[8:9], v[8:9], 0, s[56:57]
    global_load_dwordx4 v[28:31], v[8:9], off nt
    v_lshl_add_u64 v[8:9], v[8:9], 0, s[56:57]
    global_load_dwordx4 v[32:35], v[8:9], off nt
    v_lshl_add_u64 v[8:9], v[8:9], 0, s[56:57]
    global_load_dwordx4 v[36:39], v[8:9], off nt
    v_lshl_add_u64 v[8:9], v[8:9], 0, s[56:57]
    global_load_dwordx4 v[40:43], v[8:9], off nt
    v_lshl_add_u64 v[8:9], v[8:9], 0, s[56:57]
    global_load_dwordx4 v[44:47], v[8:9], off nt
    s_barrier
    s_waitcnt vmcnt(8)
    s_branch L_ln
L_a1:
    s_mul_i32 s40, s28, 14
    s_add_u32 s40, s40, s29
    s_sub_u32 s40, s40, 16
    s_and_b32 s48, s40, 3
    s_lshr_b32 s40, s40, 2
    s_lshl_b32 s43, s48, 2
    s_add_u32 s43, s43, s3
    s_add_u32 s49, s40, 2
    s_sub_u32 s41, s49, 28
    s_cmp_ge_u32 s49, 28
    s_cselect_b32 s49, s41, s49
    s_mul_i32 s41, s43, 114688
    s_lshl_b32 s43, s43, 6
    s_movk_i32 s56, 3584
    s_mov_b32 s42, 0
    s_lshl_b32 s30, s40, 7
    s_lshl_b32 s32, s49, 7
    s_waitcnt lgkmcnt(0)
    s_add_u32 s38, s4, s34
    s_addc_u32 s39, s5, 0
    global_load_dwordx4 v[152:155], v4, s[38:39]
    s_add_u32 s30, s30, s16
    s_addc_u32 s31, s17, 0
    s_add_u32 s32, s32, s18
    s_addc_u32 s33, s19, 0
    v_mul_u32_u24 v10, s42, v6
    v_lshl_add_u32 v10, v3, 3, v10
    v_mul_u32_u24 v10, s56, v10
    v_lshl_add_u32 v10, v5, 4, v10
    v_add_u32 v10, s41, v10
    v_cmp_gt_u32 vcc, 8, v2
    v_mov_b32 v8, s32
    v_mov_b32 v9, s30
    v_mov_b32 v11, s33
    v_mov_b32 v12, s31
    v_cndmask_b32 v8, v8, v9, vcc
    v_cndmask_b32 v9, v11, v12, vcc
    s_mul_i32 s36, s56, 25
    s_mov_b32 s57, 0
    s_mov_b32 s37, 0
    v_add_co_u32 v8, vcc, v8, v10
    s_nop 1
    v_addc_co_u32 v9, vcc, 0, v9, vcc
    s_load_dword s54, s[26:27], 0
    global_load_dwordx4 v[16:19], v[8:9], off nt
    v_lshl_add_u64 v[8:9], v[8:9], 0, s[56:57]
    global_load_dwordx4 v[20:23], v[8:9], off nt
    v_lshl_add_u64 v[8:9], v[8:9], 0, s[56:57]
    global_load_dwordx4 v[24:27], v[8:9], off nt
    v_lshl_add_u64 v[8:9], v[8:9], 0, s[56:57]
    global_load_dwordx4 v[28:31], v[8:9], off nt
    v_lshl_add_u64 v[8:9], v[8:9], 0, s[56:57]
    global_load_dwordx4 v[32:35], v[8:9], off nt
    v_lshl_add_u64 v[8:9], v[8:9], 0, s[56:57]
    global_load_dwordx4 v[36:39], v[8:9], off nt
    v_lshl_add_u64 v[8:9], v[8:9], 0, s[56:57]
    global_load_dwordx4 v[40:43], v[8:9], off nt
    v_lshl_add_u64 v[8:9], v[8:9], 0, s[56:57]
    global_load_dwordx4 v[44:47], v[8:9], off nt
    s_barrier
    s_waitcnt vmcnt(8)
L_ln:
    v_lshlrev_b32 v80, 16, v152
    v_and_b32 v81, 0xffff0000, v152
    v_lshlrev_b32 v82, 16, v153
    v_and_b32 v83, 0xffff0000, v153
    v_lshlrev_b32 v84, 16, v154
    v_and_b32 v85, 0xffff0000, v154
    v_lshlrev_b32 v86, 16, v155
    v_and_b32 v87, 0xffff0000, v155
    v_add_f32 v88, v80, v81
    v_add_f32 v89, v82, v83
    v_add_f32 v90, v84, v85
    v_add_f32 v91, v86, v87
    v_add_f32 v88, v88, v89
    v_add_f32 v90, v90, v91
    v_add_f32 v88, v88, v90
    s_nop 1
    v_add_f32_dpp v88, v88, v88 quad_perm:[1,0,3,2] row_mask:0xf bank_mask:0xf
    s_nop 1
    v_add_f32_dpp v88, v88, v88 quad_perm:[2,3,0,1] row_mask:0xf bank_mask:0xf
    s_nop 1
    v_add_f32_dpp v88, v88, v88 row_ror:4 row_mask:0xf bank_mask:0xf
    s_nop 1
    v_add_f32_dpp v88, v88, v88 row_ror:8 row_mask:0xf bank_mask:0xf
    v_mov_b32 v89, v88
    s_nop 1
    v_permlane16_swap_b32 v88, v89
    v_add_f32 v88, v88, v89
    v_mov_b32 v89, v88
    s_nop 1
    v_permlane32_swap_b32 v88, v89
    v_add_f32 v88, v88, v89
    v_mul_f32 v88, 0x3b000000, v88
    v_sub_f32 v92, v80, v88
    v_sub_f32 v93, v81, v88
    v_sub_f32 v94, v82, v88
    v_sub_f32 v95, v83, v88
    v_sub_f32 v96, v84, v88
    v_sub_f32 v97, v85, v88
    v_sub_f32 v98, v86, v88
    v_sub_f32 v99, v87, v88
    v_mul_f32 v90, v92, v92
    v_mul_f32 v91, v93, v93
    v_fmac_f32 v90, v94, v94
    v_fmac_f32 v91, v95, v95
    v_fmac_f32 v90, v96, v96
    v_fmac_f32 v91, v97, v97
    v_fmac_f32 v90, v98, v98
    v_fmac_f32 v91, v99, v99
    v_add_f32 v90, v90, v91
    v_cvt_pk_bf16_f32 v88, v88, v88
    v_and_b32 v88, 0xffff0000, v88
    v_add_f32_dpp v90, v90, v90 quad_perm:[1,0,3,2] row_mask:0xf bank_mask:0xf
    s_nop 1
    v_add_f32_dpp v90, v90, v90 quad_perm:[2,3,0,1] row_mask:0xf bank_mask:0xf
    s_nop 1
    v_add_f32_dpp v90, v90, v90 row_ror:4 row_mask:0xf bank_mask:0xf
    s_nop 1
    v_add_f32_dpp v90, v90, v90 row_ror:8 row_mask:0xf bank_mask:0xf
    v_mov_b32 v89, v90
    s_nop 1
    v_permlane16_swap_b32 v90, v89
    v_add_f32 v90, v90, v89
    v_mov_b32 v89, v90
    s_nop 1
    v_permlane32_swap_b32 v90, v89
    v_add_f32 v90, v90, v89
    v_sub_f32 v92, v80, v88
    v_sub_f32 v93, v81, v88
    v_sub_f32 v94, v82, v88
    v_sub_f32 v95, v83, v88
    v_sub_f32 v96, v84, v88
    v_sub_f32 v97, v85, v88
    v_sub_f32 v98, v86, v88
    v_sub_f32 v99, v87, v88
    v_mul_f32 v90, 0x3b000000, v90
    v_cvt_pk_bf16_f32 v90, v90, v90
    v_and_b32 v90, 0xffff0000, v90
    v_add_f32 v90, 0x3727c5ac, v90
    v_cvt_pk_bf16_f32 v90, v90, v90
    v_and_b32 v90, 0xffff0000, v90
    v_sqrt_f32 v90, v90
    v_cvt_pk_bf16_f32 v80, v92, v93
    v_cvt_pk_bf16_f32 v81, v94, v95
    v_cvt_pk_bf16_f32 v82, v96, v97
    v_cvt_pk_bf16_f32 v83, v98, v99
    v_cvt_pk_bf16_f32 v90, v90, v90
    v_and_b32 v90, 0xffff0000, v90
    v_rcp_f32 v90, v90
    v_lshlrev_b32 v92, 16, v80
    v_and_b32 v93, 0xffff0000, v80
    v_lshlrev_b32 v94, 16, v81
    v_and_b32 v95, 0xffff0000, v81
    v_lshlrev_b32 v96, 16, v82
    v_and_b32 v97, 0xffff0000, v82
    v_lshlrev_b32 v98, 16, v83
    v_and_b32 v99, 0xffff0000, v83
    v_mul_f32 v92, v92, v90
    v_mul_f32 v93, v93, v90
    v_mul_f32 v94, v94, v90
    v_mul_f32 v95, v95, v90
    v_mul_f32 v96, v96, v90
    v_mul_f32 v97, v97, v90
    v_mul_f32 v98, v98, v90
    v_mul_f32 v99, v99, v90
    s_mul_i32 s41, s3, 1088
    s_add_u32 s41, s41, 512
    v_add_u32 v7, s41, v4
    v_cvt_pk_bf16_f32 v80, v92, v93
    v_cvt_pk_bf16_f32 v81, v94, v95
    v_cvt_pk_bf16_f32 v82, v96, v97
    v_cvt_pk_bf16_f32 v83, v98, v99
    ds_write_b128 v7, v[80:83]
    s_waitcnt lgkmcnt(0)
    s_mov_b64 exec, 1
    ds_add_u32 v14, v15 offset:0
    s_mov_b64 exec, -1
    s_mov_b64 exec, 1
    ds_add_u32 v14, v15 offset:8
    s_mov_b64 exec, -1
    s_mul_i32 s54, s54, 1664525
    s_add_u32 s54, s54, 1013904223
    s_mov_b32 s44, s26
    s_mov_b32 s45, s27
    s_mov_b32 s46, 2752512
    s_mov_b32 s47, 0x20000
    v_lshrrev_b32 v7, 2, v2
    s_movk_i32 s41, 1088
    v_mul_u32_u24 v7, s41, v7
    v_lshl_add_u32 v7, v3, 4, v7
    v_and_b32 v10, 1, v2
    s_lshl_b32 s42, s42, 1
    v_mul_u32_u24 v10, s42, v10
    s_add_u32 s41, s43, 512
    v_add3_u32 v7, v7, v10, s41
    v_add_u32 v10, 9472, v4
    s_lshl_b32 s41, s3, 11
    v_add_u32 v11, s41, v10
    s_mov_b32 s60, 0x07060500
    s_mov_b32 s61, 0x07060501
    s_mov_b32 s62, 0x07060502
    s_mov_b32 s63, 0x07060503
    v_mov_b32 v156, s54
    s_cmp_ge_u32 s29, 16
    s_cbranch_scc1 L_gu1
    v_lshlrev_b32 v12, 12, v3
    v_lshl_add_u32 v12, v5, 5, v12
    v_lshl_add_u32 v13, v6, 4, v12
    s_lshr_b32 s48, s40, 3
    s_lshl_b32 s48, s48, 14
    s_bfe_u32 s41, s40, 0x20001
    s_lshl_b32 s41, s41, 10
    s_add_u32 s48, s48, s41
    s_and_b32 s41, s43, 512
    s_add_u32 s48, s48, s41
    s_and_b32 s41, s40, 1
    s_lshl_b32 s41, s41, 8
    s_add_u32 s48, s48, s41
    s_add_u32 s48, s48, 131072
    s_mov_b32 s59, 0x40000
L_lw1:
    ds_read_b32 v12, v14 offset:0
    s_waitcnt lgkmcnt(0)
    v_readfirstlane_b32 s58, v12
    s_nop 0
    s_cmp_ge_u32 s58, 4
    s_cbranch_scc1 L_lw1_d
    s_sub_u32 s59, s59, 1
    s_cbranch_scc0 L_lw1
L_lw1_d:
    ds_read_b128 v[144:147], v7
    s_waitcnt vmcnt(6)
    v_perm_b32 v80, v20, v16, s50
    v_perm_b32 v84, v20, v16, s51
    v_perm_b32 v88, v21, v17, s50
    v_perm_b32 v92, v21, v17, s51
    v_perm_b32 v96, v22, v18, s50
    v_perm_b32 v100, v22, v18, s51
    v_perm_b32 v104, v23, v19, s50
    v_perm_b32 v108, v23, v19, s51
    s_waitcnt vmcnt(4)
    v_perm_b32 v81, v28, v24, s50
    v_perm_b32 v85, v28, v24, s51
    v_perm_b32 v89, v29, v25, s50
    v_perm_b32 v93, v29, v25, s51
    v_perm_b32 v97, v30, v26, s50
    v_perm_b32 v101, v30, v26, s51
    v_perm_b32 v105, v31, v27, s50
    v_perm_b32 v109, v31, v27, s51
    s_waitcnt vmcnt(2)
    v_perm_b32 v82, v36, v32, s50
    v_perm_b32 v86, v36, v32, s51
    v_perm_b32 v90, v37, v33, s50
    v_perm_b32 v94, v37, v33, s51
    v_perm_b32 v98, v38, v34, s50
    v_perm_b32 v102, v38, v34, s51
    v_perm_b32 v106, v39, v35, s50
    v_perm_b32 v110, v39, v35, s51
    s_waitcnt vmcnt(0)
    v_perm_b32 v83, v44, v40, s50
    v_perm_b32 v87, v44, v40, s51
    v_perm_b32 v91, v45, v41, s50
    v_perm_b32 v95, v45, v41, s51
    v_perm_b32 v99, v46, v42, s50
    v_perm_b32 v103, v46, v42, s51
    v_perm_b32 v107, v47, v43, s50
    v_perm_b32 v111, v47, v43, s51
    s_waitcnt lgkmcnt(0)
    v_mfma_f32_16x16x32_bf16 v[16:19], v[144:147], v[80:83], 0
    v_mfma_f32_16x16x32_bf16 v[20:23], v[144:147], v[84:87], 0
    v_mfma_f32_16x16x32_bf16 v[24:27], v[144:147], v[88:91], 0
    v_mfma_f32_16x16x32_bf16 v[28:31], v[144:147], v[92:95], 0
    v_mfma_f32_16x16x32_bf16 v[32:35], v[144:147], v[96:99], 0
    v_mfma_f32_16x16x32_bf16 v[36:39], v[144:147], v[100:103], 0
    v_mfma_f32_16x16x32_bf16 v[40:43], v[144:147], v[104:107], 0
    v_mfma_f32_16x16x32_bf16 v[44:47], v[144:147], v[108:111], 0
    s_nop 0
    v_add_f32_dpp v48, v17, v16 row_ror:8 row_mask:0xf bank_mask:0x3
    v_add_f32_dpp v49, v21, v20 row_ror:8 row_mask:0xf bank_mask:0x3
    v_add_f32_dpp v50, v25, v24 row_ror:8 row_mask:0xf bank_mask:0x3
    v_add_f32_dpp v51, v29, v28 row_ror:8 row_mask:0xf bank_mask:0x3
    v_add_f32_dpp v48, v32, v33 row_ror:8 row_mask:0xf bank_mask:0xc
    v_add_f32_dpp v49, v36, v37 row_ror:8 row_mask:0xf bank_mask:0xc
    v_add_f32_dpp v50, v40, v41 row_ror:8 row_mask:0xf bank_mask:0xc
    v_add_f32_dpp v51, v44, v45 row_ror:8 row_mask:0xf bank_mask:0xc
    ds_write_b128 v11, v[48:51]
    s_waitcnt lgkmcnt(0)
    s_mov_b64 exec, 1
    ds_add_rtn_u32 v12, v14, v15 offset:4
    s_mov_b64 exec, -1
    s_waitcnt lgkmcnt(0)
    v_readfirstlane_b32 s41, v12
    s_nop 0
    s_cmp_lg_u32 s41, 3
    s_cbranch_scc1 L_q3
    ds_read_b128 v[16:19], v10 offset:0
    ds_read_b128 v[20:23], v10 offset:2048
    ds_read_b128 v[24:27], v10 offset:4096
    ds_read_b128 v[28:31], v10 offset:6144
    s_waitcnt lgkmcnt(2)
    v_pk_add_f32 v[16:17], v[16:17], v[20:21]
    v_pk_add_f32 v[18:19], v[18:19], v[22:23]
    s_waitcnt lgkmcnt(0)
    v_pk_add_f32 v[24:25], v[24:25], v[28:29]
    v_pk_add_f32 v[26:27], v[26:27], v[30:31]
    v_pk_add_f32 v[16:17], v[16:17], v[24:25]
    v_pk_add_f32 v[18:19], v[18:19], v[26:27]
    v_perm_b32 v16, v16, v156, s60
    v_perm_b32 v17, v17, v156, s61
    v_perm_b32 v18, v18, v156, s62
    v_perm_b32 v19, v19, v156, s63
    buffer_store_dwordx4 v[16:19], v13, s[44:47], s48 offen sc1
L_q3:
    s_cmp_ge_u32 s29, 8
    s_cbranch_scc1 L_dn
    s_cmp_gt_u32 s3, 1
    s_cbranch_scc1 L_aend
    s_setprio 0
    s_mov_b32 s38, 0x0c0c0400
    s_mov_b32 s39, 0x04000c0c
    s_lshl_b32 s40, s28, 3
    s_add_u32 s40, s40, s29
    s_lshl_b32 s48, s40, 14
    s_add_u32 s48, s48, 1048576
    s_add_u32 s49, s48, 8192
    s_add_u32 s43, s48, 4096
    v_lshrrev_b32 v7, 1, v5
    v_lshlrev_b32 v7, 10, v7
    v_and_b32 v10, 1, v5
    v_lshl_add_u32 v7, v10, 3, v7
    v_lshl_add_u32 v7, v3, 1, v7
    s_lshl_b32 s41, s40, 4
    v_add_u32 v7, s41, v7
    v_lshlrev_b32 v8, 2, v1
    v_add_u32 v8, 8320, v8
    s_cmp_eq_u32 s3, 0
    s_cbranch_scc1 L_fin0
    v_mov_b32 v28, 0xff
    v_and_b32 v28, s54, v28
    v_bfe_u32 v29, s54, 8, 8
    v_bfe_u32 v30, s54, 16, 8
    v_bfe_u32 v31, s54, 24, 8
    s_mov_b32 s59, 0x40000
L_lw2:
    ds_read_b32 v12, v14 offset:16
    s_waitcnt lgkmcnt(0)
    v_readfirstlane_b32 s58, v12
    s_nop 0
    s_cmp_ge_u32 s58, 4
    s_cbranch_scc1 L_lw2_d
    s_sleep 4
    s_sub_u32 s59, s59, 1
    s_cbranch_scc0 L_lw2
L_lw2_d:
    s_mov_b32 s59, 0x8000
    s_mov_b64 s[80:81], -1
    s_mov_b64 s[82:83], -1
    s_mov_b64 s[84:85], -1
    s_mov_b32 s86, -1
    s_mov_b32 s87, 0
L_dpoll:
    s_mov_b64 exec, s[80:81]
    buffer_load_dwordx4 v[16:19], v4, s[44:47], s49 offen offset:0 sc1
    s_mov_b64 exec, s[82:83]
    buffer_load_dwordx4 v[20:23], v4, s[44:47], s49 offen offset:1024 sc1
    s_mov_b64 exec, s[84:85]
    buffer_load_dwordx4 v[24:27], v4, s[44:47], s49 offen offset:2048 sc1
    s_mov_b64 exec, s[86:87]
    buffer_load_dwordx4 v[28:31], v4, s[44:47], s49 offen offset:3072 sc1
    s_mov_b64 exec, -1
    s_waitcnt vmcnt(0)
    v_perm_b32 v32, v17, v16, s38
    v_perm_b32 v33, v19, v18, s39
    v_or_b32 v32, v32, v33
    v_cmp_ne_u32 s[80:81], s54, v32
    v_perm_b32 v32, v21, v20, s38
    v_perm_b32 v33, v23, v22, s39
    v_or_b32 v32, v32, v33
    v_cmp_ne_u32 s[82:83], s54, v32
    v_perm_b32 v32, v25, v24, s38
    v_perm_b32 v33, v27, v26, s39
    v_or_b32 v32, v32, v33
    v_cmp_ne_u32 s[84:85], s54, v32
    v_perm_b32 v32, v29, v28, s38
    v_perm_b32 v33, v31, v30, s39
    v_or_b32 v32, v32, v33
    v_cmp_ne_u32 s[86:87], s54, v32
    s_or_b64 s[30:31], s[80:81], s[82:83]
    s_or_b64 s[30:31], s[30:31], s[84:85]
    s_or_b64 s[30:31], s[30:31], s[86:87]
    s_cbranch_scc0 L_dok
    s_sleep 4
    s_sub_u32 s59, s59, 1
    s_cbranch_scc0 L_dpoll
L_dok:
    v_pk_add_f32 v[16:17], v[16:17], v[20:21]
    v_pk_add_f32 v[18:19], v[18:19], v[22:23]
    v_pk_add_f32 v[24:25], v[24:25], v[28:29]
    v_pk_add_f32 v[26:27], v[26:27], v[30:31]
    v_pk_add_f32 v[16:17], v[16:17], v[24:25]
    v_pk_add_f32 v[18:19], v[18:19], v[26:27]
    s_nop 0
    v_permlane16_swap_b32 v16, v17
    v_permlane16_swap_b32 v18, v19
    v_add_f32 v16, v16, v17
    v_add_f32 v18, v18, v19
    s_nop 1
    v_permlane32_swap_b32 v16, v18
    v_add_f32 v16, v16, v18
    s_nop 1
    v_add_f32_dpp v16, v16, v16 row_ror:8 row_mask:0xf bank_mask:0xf
    v_cvt_pk_bf16_f32 v16, v16, v16
    v_and_b32 v16, 0xffff0000, v16
    v_mul_f32 v17, s52, v16
    v_exp_f32 v17, -v17
    s_nop 0
    v_add_f32 v17, 1.0, v17
    v_rcp_f32 v17, v17
    s_nop 0
    v_mul_f32 v17, v17, v16
    v_cvt_pk_bf16_f32 v17, v17, v17
    v_and_b32 v17, 0xffff0000, v17
    ds_write_b32 v8, v17
    s_waitcnt lgkmcnt(0)
    s_mov_b64 exec, 1
    ds_add_u32 v14, v15 offset:24
    s_mov_b64 exec, -1
    s_branch L_aend
L_fin0:
    global_load_ushort v61, v7, s[4:5]
    s_mov_b32 s59, 0x40000
L_lw3:
    ds_read_b32 v12, v14 offset:16
    s_waitcnt lgkmcnt(0)
    v_readfirstlane_b32 s58, v12
    s_nop 0
    s_cmp_ge_u32 s58, 4
    s_cbranch_scc1 L_lw3_d
    s_sleep 4
    s_sub_u32 s59, s59, 1
    s_cbranch_scc0 L_lw3
L_lw3_d:
    s_mov_b32 s55, 0x8000
    v_lshlrev_b32 v9, 10, v1
    s_mov_b64 exec, 0xff
L_spoll:
    buffer_load_dwordx4 v[64:67], v9, s[44:47], s48 offen sc1
    s_waitcnt vmcnt(0)
    v_perm_b32 v32, v65, v64, s38
    v_perm_b32 v33, v67, v66, s39
    v_or_b32 v32, v32, v33
    v_cmp_eq_u32 vcc, s54, v32
    s_nop 0
    s_cbranch_vccnz L_sok
    s_sleep 2
    s_sub_u32 s55, s55, 1
    s_cbranch_scc0 L_spoll
L_sok:
    s_mov_b32 s55, 0x8000
    s_mov_b64 s[80:81], -1
    s_mov_b64 s[82:83], -1
    s_mov_b64 s[84:85], -1
    s_mov_b64 s[86:87], -1
    s_mov_b64 s[88:89], -1
    s_mov_b64 s[90:91], -1
    s_mov_b64 s[92:93], -1
    s_mov_b64 s[94:95], -1
L_fpoll:
    s_mov_b64 exec, s[80:81]
    buffer_load_dwordx4 v[64:67], v4, s[44:47], s48 offen offset:0 sc1
    s_mov_b64 exec, s[82:83]
    buffer_load_dwordx4 v[68:71], v4, s[44:47], s48 offen offset:1024 sc1
    s_mov_b64 exec, s[84:85]
    buffer_load_dwordx4 v[72:75], v4, s[44:47], s48 offen offset:2048 sc1
    s_mov_b64 exec, s[86:87]
    buffer_load_dwordx4 v[76:79], v4, s[44:47], s48 offen offset:3072 sc1
    s_mov_b64 exec, s[88:89]
    buffer_load_dwordx4 v[80:83], v4, s[44:47], s43 offen offset:0 sc1
    s_mov_b64 exec, s[90:91]
    buffer_load_dwordx4 v[84:87], v4, s[44:47], s43 offen offset:1024 sc1
    s_mov_b64 exec, s[92:93]
    buffer_load_dwordx4 v[88:91], v4, s[44:47], s43 offen offset:2048 sc1
    s_mov_b64 exec, s[94:95]
    buffer_load_dwordx4 v[92:95], v4, s[44:47], s43 offen offset:3072 sc1
    s_mov_b64 exec, -1
    s_waitcnt vmcnt(7)
    v_perm_b32 v32, v65, v64, s38
    v_perm_b32 v33, v67, v66, s39
    v_or_b32 v32, v32, v33
    v_cmp_ne_u32 s[80:81], s54, v32
    s_waitcnt vmcnt(6)
    v_perm_b32 v32, v69, v68, s38
    v_perm_b32 v33, v71, v70, s39
    v_pk_add_f32 v[96:97], v[68:69], v[64:65]
    v_or_b32 v32, v32, v33
    v_pk_add_f32 v[98:99], v[70:71], v[66:67]
    v_cmp_ne_u32 s[82:83], s54, v32
    s_waitcnt vmcnt(5)
    v_perm_b32 v32, v73, v72, s38
    v_perm_b32 v33, v75, v74, s39
    v_pk_add_f32 v[96:97], v[72:73], v[96:97]
    v_or_b32 v32, v32, v33
    v_pk_add_f32 v[98:99], v[74:75], v[98:99]
    v_cmp_ne_u32 s[84:85], s54, v32
    s_or_b64 s[30:31], s[80:81], s[82:83]
    s_waitcnt vmcnt(4)
    v_perm_b32 v32, v77, v76, s38
    v_perm_b32 v33, v79, v78, s39
    v_pk_add_f32 v[96:97], v[76:77], v[96:97]
    v_or_b32 v32, v32, v33
    v_pk_add_f32 v[98:99], v[78:79], v[98:99]
    v_cmp_ne_u32 s[86:87], s54, v32
    s_or_b64 s[30:31], s[30:31], s[84:85]
    s_waitcnt vmcnt(3)
    ds_read_b32 v18, v14 offset:24
    ds_read_b32 v17, v8
    v_perm_b32 v32, v81, v80, s38
    v_perm_b32 v33, v83, v82, s39
    v_pk_add_f32 v[96:97], v[80:81], v[96:97]
    v_or_b32 v32, v32, v33
    v_pk_add_f32 v[98:99], v[82:83], v[98:99]
    v_cmp_ne_u32 s[88:89], s54, v32
    s_or_b64 s[30:31], s[30:31], s[86:87]
    s_waitcnt vmcnt(2)
    v_perm_b32 v32, v85, v84, s38
    v_perm_b32 v33, v87, v86, s39
    v_pk_add_f32 v[96:97], v[84:85], v[96:97]
    v_or_b32 v32, v32, v33
    v_pk_add_f32 v[98:99], v[86:87], v[98:99]
    v_cmp_ne_u32 s[90:91], s54, v32
    s_or_b64 s[30:31], s[30:31], s[88:89]
    s_waitcnt vmcnt(1)
    v_perm_b32 v32, v89, v88, s38
    v_perm_b32 v33, v91, v90, s39
    v_pk_add_f32 v[96:97], v[88:89], v[96:97]
    v_or_b32 v32, v32, v33
    v_pk_add_f32 v[98:99], v[90:91], v[98:99]
    v_cmp_ne_u32 s[92:93], s54, v32
    s_or_b64 s[30:31], s[30:31], s[90:91]
    s_waitcnt vmcnt(0)
    v_perm_b32 v32, v93, v92, s38
    v_perm_b32 v33, v95, v94, s39
    v_pk_add_f32 v[96:97], v[92:93], v[96:97]
    v_or_b32 v32, v32, v33
    v_pk_add_f32 v[98:99], v[94:95], v[98:99]
    v_cmp_ne_u32 s[94:95], s54, v32
    s_or_b64 s[30:31], s[30:31], s[92:93]
    v_permlane16_swap_b32 v96, v97
    v_permlane16_swap_b32 v98, v99
    s_or_b64 s[30:31], s[30:31], s[94:95]
    s_cbranch_scc0 L_fok
    s_sub_u32 s55, s55, 1
    s_cbranch_scc0 L_fpoll
L_fok:
    v_add_f32 v96, v96, v97
    v_add_f32 v98, v98, v99
    s_nop 1
    v_permlane32_swap_b32 v96, v98
    v_add_f32 v64, v96, v98
    s_nop 1
    v_add_f32_dpp v64, v64, v64 row_ror:8 row_mask:0xf bank_mask:0xf
    v_lshlrev_b32 v61, 16, v61
    s_waitcnt lgkmcnt(0)
    v_readfirstlane_b32 s58, v18
    v_cvt_pk_bf16_f32 v64, v64, v64
    v_and_b32 v64, 0xffff0000, v64
    s_cmp_lg_u32 s58, 0
    s_cbranch_scc1 L_gok
    s_mov_b32 s59, 0x40000
L_lw4:
    ds_read_b32 v12, v14 offset:24
    s_waitcnt lgkmcnt(0)
    v_readfirstlane_b32 s58, v12
    s_nop 0
    s_cmp_ge_u32 s58, 1
    s_cbranch_scc1 L_lw4_d
    s_sub_u32 s59, s59, 1
    s_cbranch_scc0 L_lw4
L_lw4_d:
    ds_read_b32 v17, v8
    s_waitcnt lgkmcnt(0)
L_gok:
    v_mul_f32 v64, v64, v17
    v_cvt_pk_bf16_f32 v64, v64, v64
    v_and_b32 v64, 0xffff0000, v64
    v_add_f32 v64, v64, v61
    v_cvt_pk_bf16_f32 v64, v64, v64
    s_mov_b32 exec_lo, 0x00ff00ff
    s_mov_b32 exec_hi, 0x00ff00ff
    global_store_short v7, v64, s[22:23]
    s_cmp_lg_u32 s40, 0
    s_cbranch_scc1 L_aend
    s_mov_b64 exec, 1
    v_mov_b32 v16, s54
    global_store_dword v14, v16, s[26:27] sc1
    s_branch L_aend
L_gu1:
    s_lshl_b32 s40, s40, 13
    s_lshl_b32 s49, s49, 13
    s_add_u32 s49, s49, 4096
    v_cmp_gt_u32 vcc, 8, v2
    v_mov_b32 v12, s49
    v_mov_b32 v13, s40
    v_cndmask_b32 v157, v12, v13, vcc
    v_lshl_add_u32 v157, v3, 8, v157
    v_lshl_add_u32 v157, v5, 4, v157
    s_lshl_b32 s48, s48, 10
    s_add_u32 s48, s48, 262144
    s_mov_b32 s59, 0x40000
L_lw5:
    ds_read_b32 v12, v14 offset:0
    s_waitcnt lgkmcnt(0)
    v_readfirstlane_b32 s58, v12
    s_nop 0
    s_cmp_ge_u32 s58, 4
    s_cbranch_scc1 L_lw5_d
    s_sub_u32 s59, s59, 1
    s_cbranch_scc0 L_lw5
L_lw5_d:
    ds_read_b128 v[144:147], v7
    s_waitcnt vmcnt(6)
    v_perm_b32 v80, v20, v16, s50
    v_perm_b32 v84, v20, v16, s51
    v_perm_b32 v88, v21, v17, s50
    v_perm_b32 v92, v21, v17, s51
    v_perm_b32 v96, v22, v18, s50
    v_perm_b32 v100, v22, v18, s51
    v_perm_b32 v104, v23, v19, s50
    v_perm_b32 v108, v23, v19, s51
    s_waitcnt vmcnt(4)
    v_perm_b32 v81, v28, v24, s50
    v_perm_b32 v85, v28, v24, s51
    v_perm_b32 v89, v29, v25, s50
    v_perm_b32 v93, v29, v25, s51
    v_perm_b32 v97, v30, v26, s50
    v_perm_b32 v101, v30, v26, s51
    v_perm_b32 v105, v31, v27, s50
    v_perm_b32 v109, v31, v27, s51
    s_waitcnt vmcnt(2)
    v_perm_b32 v82, v36, v32, s50
    v_perm_b32 v86, v36, v32, s51
    v_perm_b32 v90, v37, v33, s50
    v_perm_b32 v94, v37, v33, s51
    v_perm_b32 v98, v38, v34, s50
    v_perm_b32 v102, v38, v34, s51
    v_perm_b32 v106, v39, v35, s50
    v_perm_b32 v110, v39, v35, s51
    s_waitcnt vmcnt(0)
    v_perm_b32 v83, v44, v40, s50
    v_perm_b32 v87, v44, v40, s51
    v_perm_b32 v91, v45, v41, s50
    v_perm_b32 v95, v45, v41, s51
    v_perm_b32 v99, v46, v42, s50
    v_perm_b32 v103, v46, v42, s51
    v_perm_b32 v107, v47, v43, s50
    v_perm_b32 v111, v47, v43, s51
    s_waitcnt lgkmcnt(0)
    v_mfma_f32_16x16x32_bf16 v[16:19], v[144:147], v[80:83], 0
    v_mfma_f32_16x16x32_bf16 v[20:23], v[144:147], v[84:87], 0
    v_mfma_f32_16x16x32_bf16 v[24:27], v[144:147], v[88:91], 0
    v_mfma_f32_16x16x32_bf16 v[28:31], v[144:147], v[92:95], 0
    v_mfma_f32_16x16x32_bf16 v[32:35], v[144:147], v[96:99], 0
    v_mfma_f32_16x16x32_bf16 v[36:39], v[144:147], v[100:103], 0
    v_mfma_f32_16x16x32_bf16 v[40:43], v[144:147], v[104:107], 0
    v_mfma_f32_16x16x32_bf16 v[44:47], v[144:147], v[108:111], 0
    s_nop 0
    v_mov_b32 v48, v16
    v_mov_b32 v49, v20
    v_mov_b32 v50, v24
    v_mov_b32 v51, v28
    v_mov_b32 v52, v32
    v_mov_b32 v53, v36
    v_mov_b32 v54, v40
    v_mov_b32 v55, v44
    ds_write_b128 v11, v[48:51]
    ds_write_b128 v11, v[52:55] offset:1024
    s_waitcnt lgkmcnt(0)
    s_mov_b64 exec, 1
    ds_add_rtn_u32 v12, v14, v15 offset:4
    s_mov_b64 exec, -1
    s_waitcnt lgkmcnt(0)
    v_readfirstlane_b32 s41, v12
    s_nop 0
    s_cmp_lg_u32 s41, 3
    s_cbranch_scc1 L_wo
    ds_read_b128 v[16:19], v10 offset:0
    ds_read_b128 v[20:23], v10 offset:1024
    ds_read_b128 v[24:27], v10 offset:2048
    ds_read_b128 v[28:31], v10 offset:3072
    ds_read_b128 v[32:35], v10 offset:4096
    ds_read_b128 v[36:39], v10 offset:5120
    ds_read_b128 v[40:43], v10 offset:6144
    ds_read_b128 v[44:47], v10 offset:7168
    s_waitcnt lgkmcnt(4)
    v_pk_add_f32 v[16:17], v[16:17], v[24:25]
    v_pk_add_f32 v[18:19], v[18:19], v[26:27]
    v_pk_add_f32 v[20:21], v[20:21], v[28:29]
    v_pk_add_f32 v[22:23], v[22:23], v[30:31]
    s_waitcnt lgkmcnt(0)
    v_pk_add_f32 v[32:33], v[32:33], v[40:41]
    v_pk_add_f32 v[34:35], v[34:35], v[42:43]
    v_pk_add_f32 v[36:37], v[36:37], v[44:45]
    v_pk_add_f32 v[38:39], v[38:39], v[46:47]
    v_pk_add_f32 v[16:17], v[16:17], v[32:33]
    v_pk_add_f32 v[18:19], v[18:19], v[34:35]
    v_pk_add_f32 v[20:21], v[20:21], v[36:37]
    v_pk_add_f32 v[22:23], v[22:23], v[38:39]
    v_perm_b32 v16, v16, v156, s60
    v_perm_b32 v17, v17, v156, s61
    v_perm_b32 v18, v18, v156, s62
    v_perm_b32 v19, v19, v156, s63
    v_perm_b32 v20, v20, v156, s60
    v_perm_b32 v21, v21, v156, s61
    v_perm_b32 v22, v22, v156, s62
    v_perm_b32 v23, v23, v156, s63
    buffer_store_dwordx4 v[16:19], v157, s[44:47], s48 offen sc1
    buffer_store_dwordx4 v[20:23], v157, s[44:47], s48 offen offset:128 sc1
    s_branch L_wo
L_sp:
    s_waitcnt lgkmcnt(0)
    s_load_dword s54, s[26:27], 0
    s_barrier
    s_mov_b32 s44, s26
    s_mov_b32 s45, s27
    s_mov_b32 s46, 2752512
    s_mov_b32 s47, 0x20000
    s_mov_b32 s60, 0x07060500
    s_mov_b32 s61, 0x07060501
    s_mov_b32 s62, 0x07060502
    s_mov_b32 s63, 0x07060503
    s_waitcnt lgkmcnt(0)
    s_mov_b64 exec, 1
    ds_add_u32 v14, v15 offset:8
    s_mov_b64 exec, -1
    s_mul_i32 s54, s54, 1664525
    s_add_u32 s54, s54, 1013904223
    v_mov_b32 v156, s54
L_wo:
    s_and_b32 s40, s29, 15
    s_lshr_b32 s41, s40, 1
    s_lshl_b32 s49, s28, 3
    s_add_u32 s49, s49, s41
    s_lshl_b32 s41, s49, 16
    s_movk_i32 s42, 32
    s_movk_i32 s56, 1024
    s_and_b32 s43, s40, 1
    s_lshl_b32 s43, s43, 2
    s_add_u32 s43, s43, s3
    s_lshl_b32 s34, s43, 7
    s_add_u32 s41, s41, s34
    v_mul_u32_u24 v10, s42, v6
    v_lshl_add_u32 v10, v3, 3, v10
    v_mul_u32_u24 v10, s56, v10
    v_lshl_add_u32 v10, v5, 4, v10
    v_add_u32 v10, s41, v10
    v_mov_b32 v8, s12
    v_mov_b32 v9, s13
    s_mul_i32 s36, s56, 25
    s_mov_b32 s57, 0
    s_mov_b32 s37, 0
    v_add_co_u32 v8, vcc, v8, v10
    s_nop 1
    v_addc_co_u32 v9, vcc, 0, v9, vcc
    v_lshlrev_b32 v10, 14, v5
    v_lshl_add_u32 v10, v3, 5, v10
    v_lshl_add_u32 v10, v6, 4, v10
    s_lshl_b32 s48, s49, 13
    s_lshl_b32 s49, s49, 7
    s_lshl_b32 s41, s43, 17
    s_add_u32 s49, s49, s41
    s_add_u32 s49, s49, 1048576
    v_lshrrev_b32 v7, 2, v2
    s_movk_i32 s41, 272
    v_mul_u32_u24 v7, s41, v7
    v_lshl_add_u32 v7, v3, 4, v7
    v_and_b32 v11, 1, v2
    s_lshl_b32 s42, s42, 1
    v_mul_u32_u24 v11, s42, v11
    s_movk_i32 s41, 8320
    v_add3_u32 v7, v7, v11, s41
    v_not_b32 v120, v156
    v_not_b32 v121, v156
    v_not_b32 v122, v156
    v_not_b32 v123, v156
    buffer_store_dwordx4 v[120:123], v10, s[44:47], s49 offen sc1
    s_lshl_b32 s41, s3, 11
    s_add_u32 s48, s48, s41
    s_add_u32 s48, s48, 2097152
    v_lshlrev_b32 v11, 4, v5
    v_lshl_add_u32 v11, v6, 3, v11
    v_lshl_add_u32 v11, v3, 1, v11
    s_mul_i32 s41, s3, 272
    s_add_u32 s41, s41, 8320
    v_add_u32 v11, s41, v11
    s_mov_b32 s59, 0x40000
L_lw6:
    ds_read_b32 v12, v14 offset:20
    s_waitcnt lgkmcnt(0)
    v_readfirstlane_b32 s58, v12
    s_nop 0
    s_cmp_ge_u32 s58, 4
    s_cbranch_scc1 L_lw6_d
    s_sleep 2
    s_sub_u32 s59, s59, 1
    s_cbranch_scc0 L_lw6
L_lw6_d:
    global_load_dwordx4 v[16:19], v[8:9], off nt
    v_lshl_add_u64 v[8:9], v[8:9], 0, s[56:57]
    global_load_dwordx4 v[20:23], v[8:9], off nt
    v_lshl_add_u64 v[8:9], v[8:9], 0, s[56:57]
    global_load_dwordx4 v[24:27], v[8:9], off nt
    v_lshl_add_u64 v[8:9], v[8:9], 0, s[56:57]
    global_load_dwordx4 v[28:31], v[8:9], off nt
    v_lshl_add_u64 v[8:9], v[8:9], 0, s[56:57]
    global_load_dwordx4 v[32:35], v[8:9], off nt
    v_lshl_add_u64 v[8:9], v[8:9], 0, s[56:57]
    global_load_dwordx4 v[36:39], v[8:9], off nt
    v_lshl_add_u64 v[8:9], v[8:9], 0, s[56:57]
    global_load_dwordx4 v[40:43], v[8:9], off nt
    v_lshl_add_u64 v[8:9], v[8:9], 0, s[56:57]
    global_load_dwordx4 v[44:47], v[8:9], off nt
    s_waitcnt vmcnt(6)
    v_perm_b32 v80, v20, v16, s50
    v_perm_b32 v84, v20, v16, s51
    v_perm_b32 v88, v21, v17, s50
    v_perm_b32 v92, v21, v17, s51
    v_perm_b32 v96, v22, v18, s50
    v_perm_b32 v100, v22, v18, s51
    v_perm_b32 v104, v23, v19, s50
    v_perm_b32 v108, v23, v19, s51
    s_waitcnt vmcnt(4)
    v_perm_b32 v81, v28, v24, s50
    v_perm_b32 v85, v28, v24, s51
    v_perm_b32 v89, v29, v25, s50
    v_perm_b32 v93, v29, v25, s51
    v_perm_b32 v97, v30, v26, s50
    v_perm_b32 v101, v30, v26, s51
    v_perm_b32 v105, v31, v27, s50
    v_perm_b32 v109, v31, v27, s51
    s_waitcnt vmcnt(2)
    v_perm_b32 v82, v36, v32, s50
    v_perm_b32 v86, v36, v32, s51
    v_perm_b32 v90, v37, v33, s50
    v_perm_b32 v94, v37, v33, s51
    v_perm_b32 v98, v38, v34, s50
    v_perm_b32 v102, v38, v34, s51
    v_perm_b32 v106, v39, v35, s50
    v_perm_b32 v110, v39, v35, s51
    s_waitcnt vmcnt(0)
    v_perm_b32 v83, v44, v40, s50
    v_perm_b32 v87, v44, v40, s51
    v_perm_b32 v91, v45, v41, s50
    v_perm_b32 v95, v45, v41, s51
    v_perm_b32 v99, v46, v42, s50
    v_perm_b32 v103, v46, v42, s51
    v_perm_b32 v107, v47, v43, s50
    v_perm_b32 v111, v47, v43, s51
    s_mov_b32 s55, 0x8000
    s_mov_b64 s[30:31], -1
    s_mov_b64 s[32:33], -1
    s_mov_b32 s59, 0x40000
L_lw7:
    ds_read_b32 v12, v14 offset:16
    s_waitcnt lgkmcnt(0)
    v_readfirstlane_b32 s58, v12
    s_nop 0
    s_cmp_ge_u32 s58, 4
    s_cbranch_scc1 L_lw7_d
    s_sleep 1
    s_sub_u32 s59, s59, 1
    s_cbranch_scc0 L_lw7
L_lw7_d:
L_opoll:
    s_mov_b64 exec, s[30:31]
    buffer_load_dwordx4 v[48:51], v4, s[44:47], s48 offen offset:0 sc1
    s_mov_b64 exec, s[32:33]
    buffer_load_dwordx4 v[52:55], v4, s[44:47], s48 offen offset:1024 sc1
    s_mov_b64 exec, -1
L_ochk:
    s_waitcnt vmcnt(0)
    v_cmp_ne_u32 s[30:31], s54, v51
    v_cmp_ne_u32 s[32:33], s54, v55
    v_max_f32 v16, v50, v54
    v_max_f32 v17, v50, v54
    s_or_b64 s[34:35], s[32:33], s[30:31]
    s_cbranch_scc0 L_ook
    s_sleep 1
    s_cmp_lt_u32 s55, 32744
    s_cselect_b32 s58, 2621440, 0
    s_xor_b32 s48, s48, s58
    s_sub_u32 s55, s55, 1
    s_cbranch_scc0 L_opoll
L_ook:
    v_permlane16_swap_b32 v16, v17
    v_lshlrev_b32 v64, 16, v48
    v_and_b32 v65, 0xffff0000, v48
    v_max_f32 v16, v16, v17
    v_max_f32 v17, v16, v17
    v_lshlrev_b32 v66, 16, v49
    v_and_b32 v67, 0xffff0000, v49
    v_permlane32_swap_b32 v16, v17
    v_lshlrev_b32 v68, 16, v52
    v_and_b32 v69, 0xffff0000, v52
    v_max_f32 v16, v16, v17
    v_sub_f32 v18, v50, v16
    v_sub_f32 v20, v54, v16
    v_exp_f32 v18, v18
    v_exp_f32 v20, v20
    v_lshlrev_b32 v70, 16, v53
    v_and_b32 v71, 0xffff0000, v53
    v_add_f32 v26, v18, v20
    v_add_f32 v27, v18, v20
    v_pk_mul_f32 v[28:29], v[64:65], v[18:19] op_sel_hi:[1,0]
    v_pk_mul_f32 v[30:31], v[66:67], v[18:19] op_sel_hi:[1,0]
    v_permlane16_swap_b32 v26, v27
    v_pk_fma_f32 v[28:29], v[68:69], v[20:21], v[28:29] op_sel_hi:[1,0,1]
    v_pk_fma_f32 v[30:31], v[70:71], v[20:21], v[30:31] op_sel_hi:[1,0,1]
    v_add_f32 v24, v26, v27
    v_add_f32 v25, v26, v27
    v_permlane16_swap_b32 v28, v29
    v_permlane16_swap_b32 v30, v31
    v_permlane32_swap_b32 v24, v25
    v_add_f32 v28, v28, v29
    v_add_f32 v30, v30, v31
    v_add_f32 v24, v24, v25
    v_rcp_f32 v24, v24
    v_permlane32_swap_b32 v28, v30
    v_add_f32 v28, v28, v30
    v_mul_f32 v28, v28, v24
    v_cvt_pk_bf16_f32 v28, v28, v28
    ds_write_b16 v11, v28
    s_waitcnt lgkmcnt(0)
    s_barrier
L_mm:
    ds_read_b128 v[144:147], v7
    s_waitcnt lgkmcnt(0)
    v_mfma_f32_16x16x32_bf16 v[16:19], v[144:147], v[80:83], 0
    v_mfma_f32_16x16x32_bf16 v[20:23], v[144:147], v[84:87], 0
    v_mfma_f32_16x16x32_bf16 v[24:27], v[144:147], v[88:91], 0
    v_mfma_f32_16x16x32_bf16 v[28:31], v[144:147], v[92:95], 0
    v_mfma_f32_16x16x32_bf16 v[32:35], v[144:147], v[96:99], 0
    v_mfma_f32_16x16x32_bf16 v[36:39], v[144:147], v[100:103], 0
    v_mfma_f32_16x16x32_bf16 v[40:43], v[144:147], v[104:107], 0
    v_mfma_f32_16x16x32_bf16 v[44:47], v[144:147], v[108:111], 0
L_msg:
    s_nop 0
    v_add_f32_dpp v48, v17, v16 row_ror:8 row_mask:0xf bank_mask:0x3
    v_add_f32_dpp v49, v21, v20 row_ror:8 row_mask:0xf bank_mask:0x3
    v_add_f32_dpp v50, v25, v24 row_ror:8 row_mask:0xf bank_mask:0x3
    v_add_f32_dpp v51, v29, v28 row_ror:8 row_mask:0xf bank_mask:0x3
    v_add_f32_dpp v48, v32, v33 row_ror:8 row_mask:0xf bank_mask:0xc
    v_add_f32_dpp v49, v36, v37 row_ror:8 row_mask:0xf bank_mask:0xc
    v_add_f32_dpp v50, v40, v41 row_ror:8 row_mask:0xf bank_mask:0xc
    v_add_f32_dpp v51, v44, v45 row_ror:8 row_mask:0xf bank_mask:0xc
    v_perm_b32 v48, v48, v156, s60
    v_perm_b32 v49, v49, v156, s61
    v_perm_b32 v50, v50, v156, s62
    v_perm_b32 v51, v51, v156, s63
    buffer_store_dwordx4 v[48:51], v10, s[44:47], s49 offen sc1
    s_branch L_aend
L_dn:
    s_cmp_ge_u32 s29, 15
    s_cbranch_scc1 L_aend
    s_mul_i32 s40, s28, 7
    s_add_u32 s40, s40, s29
    s_sub_u32 s40, s40, 8
    s_lshr_b32 s41, s40, 1
    s_add_u32 s49, s41, 64
    s_lshl_b32 s41, s41, 16
    s_movk_i32 s42, 32
    s_movk_i32 s56, 1024
    s_and_b32 s43, s40, 1
    s_lshl_b32 s43, s43, 2
    s_add_u32 s43, s43, s3
    s_lshl_b32 s34, s43, 7
    s_add_u32 s41, s41, s34
    v_mul_u32_u24 v10, s42, v6
    v_lshl_add_u32 v10, v3, 3, v10
    v_mul_u32_u24 v10, s56, v10
    v_lshl_add_u32 v10, v5, 4, v10
    v_add_u32 v10, s41, v10
    v_mov_b32 v8, s20
    v_mov_b32 v9, s21
    s_mul_i32 s36, s56, 25
    s_mov_b32 s57, 0
    s_mov_b32 s37, 0
    v_add_co_u32 v8, vcc, v8, v10
    s_nop 1
    v_addc_co_u32 v9, vcc, 0, v9, vcc
    v_lshlrev_b32 v10, 14, v5
    v_lshl_add_u32 v10, v3, 5, v10
    v_lshl_add_u32 v10, v6, 4, v10
    s_lshl_b32 s48, s49, 13
    s_lshl_b32 s49, s49, 7
    s_lshl_b32 s41, s43, 17
    s_add_u32 s49, s49, s41
    s_add_u32 s49, s49, 1048576
    v_lshrrev_b32 v7, 2, v2
    s_movk_i32 s41, 272
    v_mul_u32_u24 v7, s41, v7
    v_lshl_add_u32 v7, v3, 4, v7
    v_and_b32 v11, 1, v2
    s_lshl_b32 s42, s42, 1
    v_mul_u32_u24 v11, s42, v11
    s_movk_i32 s41, 8320
    v_add3_u32 v7, v7, v11, s41
    v_not_b32 v120, v156
    v_not_b32 v121, v156
    v_not_b32 v122, v156
    v_not_b32 v123, v156
    buffer_store_dwordx4 v[120:123], v10, s[44:47], s49 offen sc1
    s_lshr_b32 s48, s40, 1
    s_lshl_b32 s48, s48, 13
    s_add_u32 s48, s48, 262144
    s_add_u32 s43, s48, 4096
    s_movk_i32 s41, 272
    v_mul_u32_u24 v11, s41, v3
    v_lshl_add_u32 v11, v5, 4, v11
    v_lshl_add_u32 v11, v6, 3, v11
    v_add_u32 v11, 8320, v11
    s_mov_b32 s38, 0x0c0c0400
    s_mov_b32 s39, 0x04000c0c
    s_setprio 0
    s_cmp_lg_u32 s3, 0
    s_cbranch_scc1 L_dn2
    s_lshl_b32 s58, s3, 2
    v_mov_b32 v13, s58
    s_mov_b32 s59, 0x40000
L_lw8:
    ds_read_b32 v12, v13 offset:32
    s_waitcnt lgkmcnt(0)
    v_readfirstlane_b32 s58, v12
    s_nop 0
    s_cmp_ge_u32 s58, 1
    s_cbranch_scc1 L_lw8_d
    s_sleep 2
    s_sub_u32 s59, s59, 1
    s_cbranch_scc0 L_lw8
L_lw8_d:
    s_mov_b32 s59, 0x8000
L_hpoll:
    buffer_load_dwordx4 v[48:51], v4, s[44:47], s48 offen offset:0 sc1
    buffer_load_dwordx4 v[52:55], v4, s[44:47], s48 offen offset:1024 sc1
    buffer_load_dwordx4 v[56:59], v4, s[44:47], s48 offen offset:2048 sc1
    buffer_load_dwordx4 v[60:63], v4, s[44:47], s48 offen offset:3072 sc1
    buffer_load_dwordx4 v[64:67], v4, s[44:47], s43 offen offset:0 sc1
    buffer_load_dwordx4 v[68:71], v4, s[44:47], s43 offen offset:1024 sc1
    buffer_load_dwordx4 v[72:75], v4, s[44:47], s43 offen offset:2048 sc1
    buffer_load_dwordx4 v[76:79], v4, s[44:47], s43 offen offset:3072 sc1
    s_waitcnt vmcnt(4)
    v_perm_b32 v112, v49, v48, s38
    v_perm_b32 v113, v51, v50, s39
    v_perm_b32 v114, v53, v52, s38
    v_perm_b32 v115, v55, v54, s39
    v_perm_b32 v116, v57, v56, s38
    v_perm_b32 v117, v59, v58, s39
    v_perm_b32 v118, v61, v60, s38
    v_perm_b32 v119, v63, v62, s39
    v_or_b32 v112, v112, v113
    v_or_b32 v114, v114, v115
    v_or_b32 v116, v116, v117
    v_or_b32 v118, v118, v119
    v_cmp_ne_u32 vcc, s54, v112
    v_cmp_ne_u32 s[30:31], s54, v114
    v_cmp_ne_u32 s[32:33], s54, v116
    v_cmp_ne_u32 s[34:35], s54, v118
    s_or_b64 s[30:31], s[30:31], s[32:33]
    s_or_b64 vcc, vcc, s[34:35]
    s_or_b64 vcc, vcc, s[30:31]
    s_mov_b64 s[40:41], vcc
    s_waitcnt vmcnt(0)
    v_perm_b32 v112, v65, v64, s38
    v_perm_b32 v113, v67, v66, s39
    v_perm_b32 v114, v69, v68, s38
    v_perm_b32 v115, v71, v70, s39
    v_perm_b32 v116, v73, v72, s38
    v_perm_b32 v117, v75, v74, s39
    v_perm_b32 v118, v77, v76, s38
    v_perm_b32 v119, v79, v78, s39
    v_or_b32 v112, v112, v113
    v_or_b32 v114, v114, v115
    v_or_b32 v116, v116, v117
    v_or_b32 v118, v118, v119
    v_cmp_ne_u32 vcc, s54, v112
    v_cmp_ne_u32 s[30:31], s54, v114
    v_cmp_ne_u32 s[32:33], s54, v116
    v_cmp_ne_u32 s[34:35], s54, v118
    s_or_b64 s[30:31], s[30:31], s[32:33]
    s_or_b64 vcc, vcc, s[34:35]
    s_or_b64 vcc, vcc, s[30:31]
    s_or_b64 vcc, vcc, s[40:41]
    s_cbranch_vccz L_hok
    s_sleep 8
    s_sub_u32 s59, s59, 1
    s_cbranch_scc0 L_hpoll
L_hok:
    v_pk_add_f32 v[48:49], v[48:49], v[52:53]
    v_pk_add_f32 v[50:51], v[50:51], v[54:55]
    v_pk_add_f32 v[56:57], v[56:57], v[60:61]
    v_pk_add_f32 v[58:59], v[58:59], v[62:63]
    v_pk_add_f32 v[48:49], v[48:49], v[56:57]
    v_pk_add_f32 v[50:51], v[50:51], v[58:59]
    v_pk_add_f32 v[64:65], v[64:65], v[68:69]
    v_pk_add_f32 v[66:67], v[66:67], v[70:71]
    v_pk_add_f32 v[72:73], v[72:73], v[76:77]
    v_pk_add_f32 v[74:75], v[74:75], v[78:79]
    v_pk_add_f32 v[64:65], v[64:65], v[72:73]
    v_pk_add_f32 v[66:67], v[66:67], v[74:75]
    v_cvt_pk_bf16_f32 v48, v48, v48
    v_and_b32 v48, 0xffff0000, v48
    v_cvt_pk_bf16_f32 v49, v49, v49
    v_and_b32 v49, 0xffff0000, v49
    v_cvt_pk_bf16_f32 v50, v50, v50
    v_and_b32 v50, 0xffff0000, v50
    v_cvt_pk_bf16_f32 v51, v51, v51
    v_and_b32 v51, 0xffff0000, v51
    v_cvt_pk_bf16_f32 v64, v64, v64
    v_and_b32 v64, 0xffff0000, v64
    v_cvt_pk_bf16_f32 v65, v65, v65
    v_and_b32 v65, 0xffff0000, v65
    v_cvt_pk_bf16_f32 v66, v66, v66
    v_and_b32 v66, 0xffff0000, v66
    v_cvt_pk_bf16_f32 v67, v67, v67
    v_and_b32 v67, 0xffff0000, v67
    v_mul_f32 v52, s52, v48
    v_mul_f32 v53, s52, v49
    v_mul_f32 v54, s52, v50
    v_mul_f32 v55, s52, v51
    v_exp_f32 v52, -v52
    v_exp_f32 v53, -v53
    v_exp_f32 v54, -v54
    v_exp_f32 v55, -v55
    v_add_f32 v52, 1.0, v52
    v_add_f32 v53, 1.0, v53
    v_add_f32 v54, 1.0, v54
    v_add_f32 v55, 1.0, v55
    v_rcp_f32 v52, v52
    v_rcp_f32 v53, v53
    v_rcp_f32 v54, v54
    v_rcp_f32 v55, v55
    v_mul_f32 v52, v52, v48
    v_mul_f32 v53, v53, v49
    v_mul_f32 v54, v54, v50
    v_mul_f32 v55, v55, v51
    v_cvt_pk_bf16_f32 v52, v52, v52
    v_and_b32 v52, 0xffff0000, v52
    v_cvt_pk_bf16_f32 v53, v53, v53
    v_and_b32 v53, 0xffff0000, v53
    v_cvt_pk_bf16_f32 v54, v54, v54
    v_and_b32 v54, 0xffff0000, v54
    v_cvt_pk_bf16_f32 v55, v55, v55
    v_and_b32 v55, 0xffff0000, v55
    v_mul_f32 v52, v52, v64
    v_mul_f32 v53, v53, v65
    v_mul_f32 v54, v54, v66
    v_mul_f32 v55, v55, v67
    v_cvt_pk_bf16_f32 v48, v52, v53
    v_cvt_pk_bf16_f32 v49, v54, v55
    ds_write_b64 v11, v[48:49]
    s_waitcnt lgkmcnt(0)
    s_mov_b64 exec, 1
    ds_add_u32 v14, v15 offset:24
    s_mov_b64 exec, -1
L_dn2:
    s_mov_b32 s59, 0x40000
L_lw9:
    ds_read_b32 v12, v14 offset:20
    s_waitcnt lgkmcnt(0)
    v_readfirstlane_b32 s58, v12
    s_nop 0
    s_cmp_ge_u32 s58, 4
    s_cbranch_scc1 L_lw9_d
    s_sleep 2
    s_sub_u32 s59, s59, 1
    s_cbranch_scc0 L_lw9
L_lw9_d:
    global_load_dwordx4 v[16:19], v[8:9], off nt
    v_lshl_add_u64 v[8:9], v[8:9], 0, s[56:57]
    global_load_dwordx4 v[20:23], v[8:9], off nt
    v_lshl_add_u64 v[8:9], v[8:9], 0, s[56:57]
    global_load_dwordx4 v[24:27], v[8:9], off nt
    v_lshl_add_u64 v[8:9], v[8:9], 0, s[56:57]
    global_load_dwordx4 v[28:31], v[8:9], off nt
    v_lshl_add_u64 v[8:9], v[8:9], 0, s[56:57]
    global_load_dwordx4 v[32:35], v[8:9], off nt
    v_lshl_add_u64 v[8:9], v[8:9], 0, s[56:57]
    global_load_dwordx4 v[36:39], v[8:9], off nt
    v_lshl_add_u64 v[8:9], v[8:9], 0, s[56:57]
    global_load_dwordx4 v[40:43], v[8:9], off nt
    v_lshl_add_u64 v[8:9], v[8:9], 0, s[56:57]
    global_load_dwordx4 v[44:47], v[8:9], off nt
    s_waitcnt vmcnt(6)
    v_perm_b32 v80, v20, v16, s50
    v_perm_b32 v84, v20, v16, s51
    v_perm_b32 v88, v21, v17, s50
    v_perm_b32 v92, v21, v17, s51
    v_perm_b32 v96, v22, v18, s50
    v_perm_b32 v100, v22, v18, s51
    v_perm_b32 v104, v23, v19, s50
    v_perm_b32 v108, v23, v19, s51
    s_waitcnt vmcnt(4)
    v_perm_b32 v81, v28, v24, s50
    v_perm_b32 v85, v28, v24, s51
    v_perm_b32 v89, v29, v25, s50
    v_perm_b32 v93, v29, v25, s51
    v_perm_b32 v97, v30, v26, s50
    v_perm_b32 v101, v30, v26, s51
    v_perm_b32 v105, v31, v27, s50
    v_perm_b32 v109, v31, v27, s51
    s_waitcnt vmcnt(2)
    v_perm_b32 v82, v36, v32, s50
    v_perm_b32 v86, v36, v32, s51
    v_perm_b32 v90, v37, v33, s50
    v_perm_b32 v94, v37, v33, s51
    v_perm_b32 v98, v38, v34, s50
    v_perm_b32 v102, v38, v34, s51
    v_perm_b32 v106, v39, v35, s50
    v_perm_b32 v110, v39, v35, s51
    s_waitcnt vmcnt(0)
    v_perm_b32 v83, v44, v40, s50
    v_perm_b32 v87, v44, v40, s51
    v_perm_b32 v91, v45, v41, s50
    v_perm_b32 v95, v45, v41, s51
    v_perm_b32 v99, v46, v42, s50
    v_perm_b32 v103, v46, v42, s51
    v_perm_b32 v107, v47, v43, s50
    v_perm_b32 v111, v47, v43, s51
    s_mov_b32 s59, 0x40000
L_lw10:
    ds_read_b32 v12, v14 offset:24
    s_waitcnt lgkmcnt(0)
    v_readfirstlane_b32 s58, v12
    s_nop 0
    s_cmp_ge_u32 s58, 1
    s_cbranch_scc1 L_lw10_d
    s_sleep 4
    s_sub_u32 s59, s59, 1
    s_cbranch_scc0 L_lw10
L_lw10_d:
    s_branch L_mm
L_kv:
    s_and_b32 s30, s29, 3
    s_lshr_b32 s31, s29, 2
    s_lshl_b32 s40, s30, 24
    s_lshl_b32 s41, s28, 21
    s_add_u32 s40, s40, s41
    s_lshl_b32 s41, s31, 16
    s_add_u32 s40, s40, s41
    s_add_u32 s40, s40, 1572864
    s_and_b32 s42, s3, 3
    s_mul_i32 s43, s28, 6
    s_mul_i32 s41, s30, 1
    s_add_u32 s43, s43, s41
    s_mul_i32 s41, s31, 4
    s_add_u32 s43, s43, s41
    s_add_u32 s43, s43, s42
    s_add_u32 s41, s43, 0
    s_and_b32 s41, s41, 15
    s_lshl_b32 s36, s41, 12
    s_add_u32 s41, s43, 4
    s_and_b32 s41, s41, 15
    s_lshl_b32 s37, s41, 12
    s_add_u32 s41, s43, 8
    s_and_b32 s41, s41, 15
    s_lshl_b32 s38, s41, 12
    s_add_u32 s41, s43, 12
    s_and_b32 s41, s41, 15
    s_lshl_b32 s39, s41, 12
    s_mov_b32 s34, 65536
    s_mov_b32 s35, 0x20000
    s_lshl_b32 s41, s42, 2
    v_mov_b32 v5, s41
    s_cmp_ge_u32 s3, 8
    s_cbranch_scc1 L_v
    v_lshlrev_b32 v4, 8, v2
    v_lshl_add_u32 v4, v3, 4, v4
    s_setprio 2
    s_waitcnt lgkmcnt(0)
    s_add_u32 s32, s6, s40
    s_addc_u32 s33, s7, 0
    s_load_dword s54, s[26:27], 0
    buffer_load_dwordx4 v[16:19], v4, s[32:35], s36 offen offset:0 nt
    buffer_load_dwordx4 v[20:23], v4, s[32:35], s36 offen offset:64 nt
    buffer_load_dwordx4 v[24:27], v4, s[32:35], s36 offen offset:128 nt
    s_barrier
    s_mov_b32 s44, s26
    s_mov_b32 s45, s27
    s_mov_b32 s46, 2752512
    s_mov_b32 s47, 0x20000
    s_lshl_b32 s48, s28, 14
    s_lshl_b32 s41, s30, 12
    s_add_u32 s48, s48, s41
    s_lshl_b32 s41, s42, 10
    s_add_u32 s48, s48, s41
    s_add_u32 s48, s48, 131072
    v_lshlrev_b32 v156, 4, v1
    buffer_load_dwordx4 v[28:31], v4, s[32:35], s36 offen offset:192 nt
    buffer_load_dwordx4 v[32:35], v4, s[32:35], s37 offen offset:0 nt
    buffer_load_dwordx4 v[36:39], v4, s[32:35], s37 offen offset:64 nt
    s_waitcnt vmcnt(5)
    buffer_load_dwordx4 v[40:43], v4, s[32:35], s37 offen offset:128 nt
    s_waitcnt vmcnt(5)
    buffer_load_dwordx4 v[44:47], v4, s[32:35], s37 offen offset:192 nt
    s_waitcnt vmcnt(5)
    buffer_load_dwordx4 v[48:51], v4, s[32:35], s38 offen offset:0 nt
    s_waitcnt vmcnt(5)
    buffer_load_dwordx4 v[52:55], v4, s[32:35], s38 offen offset:64 nt
    s_waitcnt vmcnt(5)
    buffer_load_dwordx4 v[56:59], v4, s[32:35], s38 offen offset:128 nt
    s_waitcnt vmcnt(5)
    buffer_load_dwordx4 v[60:63], v4, s[32:35], s38 offen offset:192 nt
    s_waitcnt vmcnt(5)
    buffer_load_dwordx4 v[64:67], v4, s[32:35], s39 offen offset:0 nt
    s_mov_b64 exec, 1
    ds_add_u32 v5, v15 offset:32
    s_mov_b64 exec, -1
    s_waitcnt vmcnt(5)
    buffer_load_dwordx4 v[68:71], v4, s[32:35], s39 offen offset:64 nt
    s_waitcnt vmcnt(5)
    buffer_load_dwordx4 v[72:75], v4, s[32:35], s39 offen offset:128 nt
    s_waitcnt vmcnt(5)
    buffer_load_dwordx4 v[76:79], v4, s[32:35], s39 offen offset:192 nt
    buffer_load_dwordx4 v[148:151], v156, s[44:47], s48 offen sc1
    s_mul_i32 s41, s42, 320
    s_add_u32 s41, s41, 4864
    v_and_b32 v13, 31, v1
    v_lshlrev_b32 v13, 3, v13
    v_lshrrev_b32 v12, 5, v1
    v_lshl_add_u32 v13, v12, 2, v13
    v_add_u32 v13, s41, v13
    s_mov_b32 s60, 0x0c0c0400
    s_mov_b32 s61, 0x04000c0c
    v_and_b32 v9, 3, v2
    s_movk_i32 s41, 320
    v_mul_u32_u24 v9, s41, v9
    v_lshl_add_u32 v9, v3, 4, v9
    v_add_u32 v9, 4864, v9
    v_lshlrev_b32 v10, 4, v3
    v_add_u32 v10, 256, v10
    v_lshrrev_b32 v11, 2, v2
    v_cmp_eq_u32 vcc, 0, v11
    s_nop 1
    v_cndmask_b32 v5, v10, v9, vcc
    v_cmp_eq_u32 vcc, 1, v11
    s_nop 1
    v_cndmask_b32 v6, v10, v9, vcc
    v_cmp_eq_u32 vcc, 2, v11
    s_nop 1
    v_cndmask_b32 v7, v10, v9, vcc
    v_cmp_eq_u32 vcc, 3, v11
    s_nop 1
    v_cndmask_b32 v8, v10, v9, vcc
    v_lshrrev_b32 v9, 1, v11
    v_lshlrev_b32 v9, 8, v9
    v_and_b32 v10, 3, v2
    v_lshl_add_u32 v9, v10, 6, v9
    v_lshl_add_u32 v9, v3, 4, v9
    v_and_b32 v12, 1, v11
    v_lshl_add_u32 v9, v12, 3, v9
    s_lshl_b32 s41, s42, 9
    s_add_u32 s41, s41, 6144
    v_add_u32 v9, s41, v9
    s_lshl_b32 s41, s42, 3
    s_add_u32 s41, s41, 8192
    v_lshlrev_b32 v10, 5, v10
    v_add_u32 v10, s41, v10
    s_mov_b32 s53, 0x3db504f3
    s_waitcnt lgkmcnt(0)
    s_mul_i32 s54, s54, 1664525
    s_add_u32 s54, s54, 1013904223
    s_mov_b32 s59, 0x8000
    s_branch L_qchk
L_qpoll:
    buffer_load_dwordx4 v[148:151], v156, s[44:47], s48 offen sc1
L_qchk:
    s_waitcnt vmcnt(0)
    v_perm_b32 v144, v149, v148, s60
    v_perm_b32 v145, v151, v150, s61
    v_or_b32 v144, v144, v145
    v_cmp_ne_u32 vcc, s54, v144
    s_nop 0
    s_cbranch_vccz L_qok
    s_sleep 1
    s_sub_u32 s59, s59, 1
    s_cbranch_scc0 L_qpoll
L_qok:
    v_permlane32_swap_b32 v148, v150
    v_permlane32_swap_b32 v149, v151
    v_pk_add_f32 v[148:149], v[148:149], v[150:151]
    v_cvt_pk_bf16_f32 v148, v148, v149
    ds_write_b32 v13, v148
    s_waitcnt lgkmcnt(0)
    s_mov_b64 exec, 1
    ds_add_u32 v14, v15 offset:8
    s_mov_b64 exec, -1
    s_mov_b32 s59, 0x40000
L_lw11:
    ds_read_b32 v12, v14 offset:8
    s_waitcnt lgkmcnt(0)
    v_readfirstlane_b32 s58, v12
    s_nop 0
    s_cmp_ge_u32 s58, 8
    s_cbranch_scc1 L_lw11_d
    s_sub_u32 s59, s59, 1
    s_cbranch_scc0 L_lw11
L_lw11_d:
    ds_read_b128 v[80:83], v5 offset:0
    ds_read_b128 v[84:87], v5 offset:64
    ds_read_b128 v[88:91], v5 offset:128
    ds_read_b128 v[92:95], v5 offset:192
    ds_read_b128 v[96:99], v6 offset:0
    ds_read_b128 v[100:103], v6 offset:64
    ds_read_b128 v[104:107], v6 offset:128
    ds_read_b128 v[108:111], v6 offset:192
    ds_read_b128 v[112:115], v7 offset:0
    ds_read_b128 v[116:119], v7 offset:64
    ds_read_b128 v[120:123], v7 offset:128
    ds_read_b128 v[124:127], v7 offset:192
    ds_read_b128 v[128:131], v8 offset:0
    ds_read_b128 v[132:135], v8 offset:64
    ds_read_b128 v[136:139], v8 offset:128
    ds_read_b128 v[140:143], v8 offset:192
    s_waitcnt lgkmcnt(15)
    v_mfma_f32_16x16x32_bf16 v[144:147], v[16:19], v[80:83], 0
    s_waitcnt lgkmcnt(14)
    v_mfma_f32_16x16x32_bf16 v[148:151], v[20:23], v[84:87], 0
    s_waitcnt lgkmcnt(13)
    v_mfma_f32_16x16x32_bf16 v[144:147], v[24:27], v[88:91], v[144:147]
    s_waitcnt lgkmcnt(12)
    v_mfma_f32_16x16x32_bf16 v[148:151], v[28:31], v[92:95], v[148:151]
    s_waitcnt lgkmcnt(11)
    v_mfma_f32_16x16x32_bf16 v[144:147], v[32:35], v[96:99], v[144:147]
    s_waitcnt lgkmcnt(10)
    v_mfma_f32_16x16x32_bf16 v[148:151], v[36:39], v[100:103], v[148:151]
    s_waitcnt lgkmcnt(9)
    v_mfma_f32_16x16x32_bf16 v[144:147], v[40:43], v[104:107], v[144:147]
    s_waitcnt lgkmcnt(8)
    v_mfma_f32_16x16x32_bf16 v[148:151], v[44:47], v[108:111], v[148:151]
    s_waitcnt lgkmcnt(7)
    v_mfma_f32_16x16x32_bf16 v[144:147], v[48:51], v[112:115], v[144:147]
    s_waitcnt lgkmcnt(6)
    v_mfma_f32_16x16x32_bf16 v[148:151], v[52:55], v[116:119], v[148:151]
    s_waitcnt lgkmcnt(5)
    v_mfma_f32_16x16x32_bf16 v[144:147], v[56:59], v[120:123], v[144:147]
    s_waitcnt lgkmcnt(4)
    v_mfma_f32_16x16x32_bf16 v[148:151], v[60:63], v[124:127], v[148:151]
    s_waitcnt lgkmcnt(3)
    v_mfma_f32_16x16x32_bf16 v[144:147], v[64:67], v[128:131], v[144:147]
    s_waitcnt lgkmcnt(2)
    v_mfma_f32_16x16x32_bf16 v[148:151], v[68:71], v[132:135], v[148:151]
    s_waitcnt lgkmcnt(1)
    v_mfma_f32_16x16x32_bf16 v[144:147], v[72:75], v[136:139], v[144:147]
    s_waitcnt lgkmcnt(0)
    v_mfma_f32_16x16x32_bf16 v[148:151], v[76:79], v[140:143], v[148:151]
    s_nop 7
    v_pk_add_f32 v[144:145], v[144:145], v[148:149]
    v_pk_add_f32 v[146:147], v[146:147], v[150:151]
    v_cvt_pk_bf16_f32 v16, v144, v145
    v_cvt_pk_bf16_f32 v17, v146, v147
    v_lshlrev_b32 v18, 16, v16
    v_and_b32 v19, 0xffff0000, v16
    v_lshlrev_b32 v20, 16, v17
    v_and_b32 v21, 0xffff0000, v17
    v_mul_f32 v18, s53, v18
    v_mul_f32 v19, s53, v19
    v_mul_f32 v20, s53, v20
    v_mul_f32 v21, s53, v21
    v_cvt_pk_bf16_f32 v16, v18, v19
    v_cvt_pk_bf16_f32 v17, v20, v21
    v_lshlrev_b32 v18, 16, v16
    v_and_b32 v19, 0xffff0000, v16
    v_lshlrev_b32 v20, 16, v17
    v_and_b32 v21, 0xffff0000, v17
    v_max3_f32 v22, v18, v19, v20
    v_max_f32 v22, v22, v21
    s_nop 1
    v_max_f32_dpp v22, v22, v22 row_ror:4 row_mask:0xf bank_mask:0xf
    s_nop 1
    v_max_f32_dpp v22, v22, v22 row_ror:8 row_mask:0xf bank_mask:0xf
    v_mov_b32 v23, v22
    s_nop 1
    v_permlane16_swap_b32 v22, v23
    v_max_f32 v22, v22, v23
    v_mov_b32 v23, v22
    s_nop 1
    v_permlane32_swap_b32 v22, v23
    v_max_f32 v22, v22, v23
    v_mul_f32 v24, s52, v22
    v_fma_f32 v18, v18, s52, -v24
    v_fma_f32 v19, v19, s52, -v24
    v_fma_f32 v20, v20, s52, -v24
    v_fma_f32 v21, v21, s52, -v24
    v_exp_f32 v18, v18
    v_exp_f32 v19, v19
    v_exp_f32 v20, v20
    v_exp_f32 v21, v21
    v_cvt_pk_bf16_f32 v16, v18, v19
    v_cvt_pk_bf16_f32 v17, v20, v21
    ds_write_b64 v9, v[16:17]
    v_add_f32 v25, v18, v19
    v_add_f32 v26, v20, v21
    v_add_f32 v25, v25, v26
    s_nop 1
    v_add_f32_dpp v25, v25, v25 row_ror:4 row_mask:0xf bank_mask:0xf
    s_nop 1
    v_add_f32_dpp v25, v25, v25 row_ror:8 row_mask:0xf bank_mask:0xf
    v_mov_b32 v23, v25
    s_nop 1
    v_permlane16_swap_b32 v25, v23
    v_add_f32 v25, v25, v23
    v_mov_b32 v23, v25
    s_nop 1
    v_permlane32_swap_b32 v25, v23
    v_add_f32 v25, v25, v23
    ds_write_b64 v10, v[24:25]
    s_waitcnt lgkmcnt(0)
    s_mov_b64 exec, 1
    ds_add_u32 v14, v15 offset:12
    s_mov_b64 exec, -1
    s_endpgm
L_v:
    v_lshlrev_b32 v4, 10, v3
    v_lshl_add_u32 v4, v2, 4, v4
    s_setprio 1
    s_waitcnt lgkmcnt(0)
    s_load_dword s54, s[26:27], 0
    s_add_u32 s32, s8, s40
    s_addc_u32 s33, s9, 0
    s_barrier
    s_mov_b32 s44, s26
    s_mov_b32 s45, s27
    s_mov_b32 s46, 2752512
    s_mov_b32 s47, 0x20000
    s_lshl_b32 s48, s30, 3
    s_add_u32 s48, s48, s31
    s_lshl_b32 s48, s48, 8
    s_lshl_b32 s41, s28, 16
    s_add_u32 s48, s48, s41
    s_add_u32 s48, s48, 524288
    v_lshrrev_b32 v6, 2, v2
    v_lshlrev_b32 v6, 6, v6
    v_lshl_add_u32 v6, v3, 4, v6
    s_lshl_b32 s41, s42, 9
    s_add_u32 s41, s41, 6144
    v_add_u32 v6, s41, v6
    v_lshlrev_b32 v7, 5, v3
    v_add_u32 v7, 8192, v7
    s_lshl_b32 s41, s42, 3
    v_add_u32 v8, s41, v7
    v_lshlrev_b32 v9, 4, v1
    v_add_u32 v9, 17664, v9
    s_lshl_b32 s41, s42, 11
    v_add_u32 v10, s41, v9
    s_waitcnt vmcnt(0) lgkmcnt(0)
    s_mul_i32 s54, s54, 1664525
    s_add_u32 s54, s54, 1013904223
    v_lshrrev_b32 v11, 3, v1
    v_lshlrev_b32 v11, 13, v11
    v_and_b32 v12, 7, v1
    v_lshl_add_u32 v11, v12, 4, v11
    v_mov_b32 v13, v5
    v_mov_b32 v5, v11
    s_add_u32 s49, s48, 1572864
    s_cmp_lt_u32 s42, 2
    s_cbranch_scc1 L_nopa
    s_and_b32 s41, s42, 1
    s_lshl_b32 s41, s41, 7
    s_add_u32 s41, s41, s49
    v_not_b32 v120, s54
    v_not_b32 v121, s54
    v_not_b32 v122, s54
    v_not_b32 v123, s54
    buffer_store_dwordx4 v[120:123], v5, s[44:47], s41 offen
L_nopa:
    s_mov_b32 s59, 0x40000
L_lw12:
    ds_read_b32 v12, v13 offset:32
    s_waitcnt lgkmcnt(0)
    v_readfirstlane_b32 s58, v12
    s_nop 0
    s_cmp_ge_u32 s58, 1
    s_cbranch_scc1 L_lw12_d
    s_sleep 2
    s_sub_u32 s59, s59, 1
    s_cbranch_scc0 L_lw12
L_lw12_d:
    buffer_load_dwordx4 v[16:19], v4, s[32:35], s36 offen offset:0 nt
    buffer_load_dwordx4 v[20:23], v4, s[32:35], s36 offen offset:256 nt
    buffer_load_dwordx4 v[24:27], v4, s[32:35], s36 offen offset:512 nt
    buffer_load_dwordx4 v[28:31], v4, s[32:35], s36 offen offset:768 nt
    buffer_load_dwordx4 v[32:35], v4, s[32:35], s37 offen offset:0 nt
    buffer_load_dwordx4 v[36:39], v4, s[32:35], s37 offen offset:256 nt
    buffer_load_dwordx4 v[40:43], v4, s[32:35], s37 offen offset:512 nt
    buffer_load_dwordx4 v[44:47], v4, s[32:35], s37 offen offset:768 nt
    s_waitcnt vmcnt(7)
    buffer_load_dwordx4 v[48:51], v4, s[32:35], s38 offen offset:0 nt
    s_waitcnt vmcnt(7)
    buffer_load_dwordx4 v[52:55], v4, s[32:35], s38 offen offset:256 nt
    v_perm_b32 v80, v20, v16, s50
    v_perm_b32 v84, v20, v16, s51
    v_perm_b32 v88, v21, v17, s50
    v_perm_b32 v92, v21, v17, s51
    v_perm_b32 v96, v22, v18, s50
    v_perm_b32 v100, v22, v18, s51
    v_perm_b32 v104, v23, v19, s50
    v_perm_b32 v108, v23, v19, s51
    s_waitcnt vmcnt(7)
    buffer_load_dwordx4 v[56:59], v4, s[32:35], s38 offen offset:512 nt
    s_waitcnt vmcnt(7)
    buffer_load_dwordx4 v[60:63], v4, s[32:35], s38 offen offset:768 nt
    v_perm_b32 v81, v28, v24, s50
    v_perm_b32 v85, v28, v24, s51
    v_perm_b32 v89, v29, v25, s50
    v_perm_b32 v93, v29, v25, s51
    v_perm_b32 v97, v30, v26, s50
    v_perm_b32 v101, v30, v26, s51
    v_perm_b32 v105, v31, v27, s50
    v_perm_b32 v109, v31, v27, s51
    s_waitcnt vmcnt(7)
    buffer_load_dwordx4 v[64:67], v4, s[32:35], s39 offen offset:0 nt
    s_waitcnt vmcnt(7)
    buffer_load_dwordx4 v[68:71], v4, s[32:35], s39 offen offset:256 nt
    v_perm_b32 v82, v36, v32, s50
    v_perm_b32 v86, v36, v32, s51
    v_perm_b32 v90, v37, v33, s50
    v_perm_b32 v94, v37, v33, s51
    v_perm_b32 v98, v38, v34, s50
    v_perm_b32 v102, v38, v34, s51
    v_perm_b32 v106, v39, v35, s50
    v_perm_b32 v110, v39, v35, s51
    s_waitcnt vmcnt(7)
    buffer_load_dwordx4 v[72:75], v4, s[32:35], s39 offen offset:512 nt
    s_waitcnt vmcnt(7)
    buffer_load_dwordx4 v[76:79], v4, s[32:35], s39 offen offset:768 nt
    v_perm_b32 v83, v44, v40, s50
    v_perm_b32 v87, v44, v40, s51
    v_perm_b32 v91, v45, v41, s50
    v_perm_b32 v95, v45, v41, s51
    v_perm_b32 v99, v46, v42, s50
    v_perm_b32 v103, v46, v42, s51
    v_perm_b32 v107, v47, v43, s50
    v_perm_b32 v111, v47, v43, s51
    s_mov_b64 exec, 1
    ds_add_u32 v14, v15 offset:20
    s_mov_b64 exec, -1
    s_mov_b32 s59, 0x40000
L_lw13:
    ds_read_b32 v12, v14 offset:12
    s_waitcnt lgkmcnt(0)
    v_readfirstlane_b32 s58, v12
    s_nop 0
    s_cmp_ge_u32 s58, 4
    s_cbranch_scc1 L_lw13_d
    s_sleep 1
    s_sub_u32 s59, s59, 1
    s_cbranch_scc0 L_lw13
L_lw13_d:
    ds_read_b128 v[144:147], v6
    ds_read_b128 v[148:151], v6 offset:256
    ds_read_b128 v[16:19], v7
    ds_read_b128 v[20:23], v7 offset:16
    ds_read_b32 v24, v8
    s_waitcnt lgkmcnt(4)
    v_mfma_f32_16x16x32_bf16 v[112:115], v[144:147], v[80:83], 0
    v_mfma_f32_16x16x32_bf16 v[116:119], v[144:147], v[84:87], 0
    v_mfma_f32_16x16x32_bf16 v[120:123], v[144:147], v[88:91], 0
    v_mfma_f32_16x16x32_bf16 v[124:127], v[144:147], v[92:95], 0
    v_mfma_f32_16x16x32_bf16 v[128:131], v[144:147], v[96:99], 0
    v_mfma_f32_16x16x32_bf16 v[132:135], v[144:147], v[100:103], 0
    v_mfma_f32_16x16x32_bf16 v[136:139], v[144:147], v[104:107], 0
    v_mfma_f32_16x16x32_bf16 v[140:143], v[144:147], v[108:111], 0
    s_waitcnt lgkmcnt(0)
    v_max3_f32 v25, v16, v18, v20
    v_max_f32 v25, v25, v22
    v_sub_f32 v16, v16, v25
    v_sub_f32 v18, v18, v25
    v_sub_f32 v20, v20, v25
    v_sub_f32 v22, v22, v25
    v_sub_f32 v24, v24, v25
    v_exp_f32 v16, v16
    v_exp_f32 v18, v18
    v_exp_f32 v20, v20
    v_exp_f32 v22, v22
    v_exp_f32 v24, v24
    v_mul_f32 v26, v16, v17
    v_fmac_f32 v26, v18, v19
    v_fmac_f32 v26, v20, v21
    v_fmac_f32 v26, v22, v23
    v_rcp_f32 v27, v26
    v_log_f32 v13, v26
    v_mul_f32 v11, v24, v27
    v_add_f32 v13, v13, v25
    s_waitcnt vmcnt(6)
    v_perm_b32 v16, v52, v48, s50
    v_perm_b32 v20, v52, v48, s51
    v_perm_b32 v24, v53, v49, s50
    v_perm_b32 v28, v53, v49, s51
    v_perm_b32 v32, v54, v50, s50
    v_perm_b32 v36, v54, v50, s51
    v_perm_b32 v40, v55, v51, s50
    v_perm_b32 v44, v55, v51, s51
    s_waitcnt vmcnt(4)
    v_perm_b32 v17, v60, v56, s50
    v_perm_b32 v21, v60, v56, s51
    v_perm_b32 v25, v61, v57, s50
    v_perm_b32 v29, v61, v57, s51
    v_perm_b32 v33, v62, v58, s50
    v_perm_b32 v37, v62, v58, s51
    v_perm_b32 v41, v63, v59, s50
    v_perm_b32 v45, v63, v59, s51
    s_waitcnt vmcnt(2)
    v_perm_b32 v18, v68, v64, s50
    v_perm_b32 v22, v68, v64, s51
    v_perm_b32 v26, v69, v65, s50
    v_perm_b32 v30, v69, v65, s51
    v_perm_b32 v34, v70, v66, s50
    v_perm_b32 v38, v70, v66, s51
    v_perm_b32 v42, v71, v67, s50
    v_perm_b32 v46, v71, v67, s51
    s_waitcnt vmcnt(0)
    v_perm_b32 v19, v76, v72, s50
    v_perm_b32 v23, v76, v72, s51
    v_perm_b32 v27, v77, v73, s50
    v_perm_b32 v31, v77, v73, s51
    v_perm_b32 v35, v78, v74, s50
    v_perm_b32 v39, v78, v74, s51
    v_perm_b32 v43, v79, v75, s50
    v_perm_b32 v47, v79, v75, s51
    v_mfma_f32_16x16x32_bf16 v[112:115], v[148:151], v[16:19], v[112:115]
    v_mfma_f32_16x16x32_bf16 v[116:119], v[148:151], v[20:23], v[116:119]
    v_mfma_f32_16x16x32_bf16 v[120:123], v[148:151], v[24:27], v[120:123]
    v_mfma_f32_16x16x32_bf16 v[124:127], v[148:151], v[28:31], v[124:127]
    v_mfma_f32_16x16x32_bf16 v[128:131], v[148:151], v[32:35], v[128:131]
    v_mfma_f32_16x16x32_bf16 v[132:135], v[148:151], v[36:39], v[132:135]
    v_mfma_f32_16x16x32_bf16 v[136:139], v[148:151], v[40:43], v[136:139]
    v_mfma_f32_16x16x32_bf16 v[140:143], v[148:151], v[44:47], v[140:143]
    s_nop 0
    v_mul_f32 v80, v11, v112
    v_mul_f32 v81, v11, v116
    v_mul_f32 v82, v11, v120
    v_mul_f32 v83, v11, v124
    v_mul_f32 v84, v11, v128
    v_mul_f32 v85, v11, v132
    v_mul_f32 v86, v11, v136
    v_mul_f32 v87, v11, v140
    ds_write_b128 v10, v[80:83]
    ds_write_b128 v10, v[84:87] offset:1024
    s_waitcnt lgkmcnt(0)
    s_mov_b64 exec, 1
    ds_add_rtn_u32 v12, v14, v15 offset:16
    s_mov_b64 exec, -1
    s_waitcnt lgkmcnt(0)
    v_readfirstlane_b32 s41, v12
    s_nop 0
    s_cmp_lg_u32 s41, 3
    s_cbranch_scc1 L_aend
    ds_read_b128 v[16:19], v9 offset:0
    ds_read_b128 v[20:23], v9 offset:1024
    ds_read_b128 v[24:27], v9 offset:2048
    ds_read_b128 v[28:31], v9 offset:3072
    ds_read_b128 v[32:35], v9 offset:4096
    ds_read_b128 v[36:39], v9 offset:5120
    ds_read_b128 v[40:43], v9 offset:6144
    ds_read_b128 v[44:47], v9 offset:7168
    v_mov_b32 v82, v13
    v_mov_b32 v83, s54
    v_mov_b32 v86, v13
    v_mov_b32 v87, s54
    s_waitcnt lgkmcnt(4)
    v_pk_add_f32 v[16:17], v[16:17], v[24:25]
    v_pk_add_f32 v[18:19], v[18:19], v[26:27]
    v_pk_add_f32 v[20:21], v[20:21], v[28:29]
    v_pk_add_f32 v[22:23], v[22:23], v[30:31]
    s_waitcnt lgkmcnt(0)
    v_pk_add_f32 v[32:33], v[32:33], v[40:41]
    v_pk_add_f32 v[34:35], v[34:35], v[42:43]
    v_pk_add_f32 v[36:37], v[36:37], v[44:45]
    v_pk_add_f32 v[38:39], v[38:39], v[46:47]
    v_pk_add_f32 v[16:17], v[16:17], v[32:33]
    v_pk_add_f32 v[18:19], v[18:19], v[34:35]
    v_pk_add_f32 v[20:21], v[20:21], v[36:37]
    v_pk_add_f32 v[22:23], v[22:23], v[38:39]
    v_cvt_pk_bf16_f32 v80, v16, v17
    v_cvt_pk_bf16_f32 v81, v18, v19
    v_cvt_pk_bf16_f32 v84, v20, v21
    v_cvt_pk_bf16_f32 v85, v22, v23
    buffer_store_dwordx4 v[80:83], v5, s[44:47], s49 offen
    buffer_store_dwordx4 v[84:87], v5, s[44:47], s49 offen offset:128
    buffer_store_dwordx4 v[80:83], v5, s[44:47], s48 offen sc1
    buffer_store_dwordx4 v[84:87], v5, s[44:47], s48 offen offset:128 sc1
L_aend:
L_end:
    s_endpgm
.fill 2560, 4, 0xbf800000
.section .rodata,"a"
.p2align 6
.amdhsa_kernel recurrent_scan__sliding_block_cached__swiglu_ffn__decode_kernel
  .amdhsa_next_free_vgpr 160
  .amdhsa_next_free_sgpr 96
  .amdhsa_accum_offset 160
  .amdhsa_group_segment_fixed_size 0
  .amdhsa_kernarg_size 96
  .amdhsa_user_sgpr_count 2
  .amdhsa_user_sgpr_kernarg_segment_ptr 1
  .amdhsa_system_sgpr_workgroup_id_x 1
.end_amdhsa_kernel
```
